```python
import torch

def _softmax(x, axis=-1):
    return torch.softmax(x, dim=axis)
def _gelu(x):
    return torch.nn.functional.gelu(x, approximate="tanh")
def _silu(x):
    return torch.nn.functional.silu(x)
def _sigmoid(x):
    return torch.sigmoid(x)
def _layernorm(x, axis=-1, eps=1e-5):
    m = x.mean(dim=axis, keepdim=True)
    v = x.var(dim=axis, keepdim=True, unbiased=False)
    return (x - m) / torch.sqrt(v + eps)
def _scatter_add(tgt, idx, src, axis=0):
    return tgt.clone().index_add_(axis, idx, src)
def _segment_sum(src, seg, n):
    out = torch.zeros((n,) + src.shape[1:], dtype=src.dtype)
    return out.index_add_(0, seg, src)
def _pad(x, pw):
    flat = tuple(v for pair in reversed(pw) for v in pair)
    return torch.nn.functional.pad(x, flat)

kernel_name = 'concat_heads__spectral_fnet__softmax_full_mha__prompt'

def setup_inputs():

    _w = (lambda a: (lambda t: t.to(torch.bfloat16) if t.is_floating_point() else t)(torch.as_tensor(a)))
    def _A_setup():
        B, S, D = 1, 2048, 576
        ns = torch.arange(S)[:, None] * torch.arange(S)[None, :]
        nd = torch.arange(D)[:, None] * torch.arange(D)[None, :]
        Ws_re = torch.cos(-2.0 * torch.pi * ns / S).to(float)
        Ws_im = torch.sin(-2.0 * torch.pi * ns / S).to(float)
        Wd_re = torch.cos(-2.0 * torch.pi * nd / D).to(float)
        Wd_im = torch.sin(-2.0 * torch.pi * nd / D).to(float)
        return {
            "x": _w((lambda *s: torch.randn(*s, dtype=torch.bfloat16) * 0.05)(B, S, D)),
            "dft_seq_re": _w(Ws_re),
            "dft_seq_im": _w(Ws_im),
            "dft_hid_re": _w(Wd_re),
            "dft_hid_im": _w(Wd_im),
        }
    _A_in = _A_setup()

    def _B_setup():
        B, S, D = 1, 2048, 576
        return {
            "x": _w((lambda *s: torch.randn(*s, dtype=torch.bfloat16) * 0.2)(B, S, D)),
            "wqkv": _w((lambda *s: torch.randn(*s, dtype=torch.bfloat16) * 0.8)(D, 3 * D)),
            "wo": _w((lambda *s: torch.randn(*s, dtype=torch.bfloat16) * 0.2)(D, D)),
        }
    _B_in = _B_setup()

    return {
        "A_x": _A_in["x"],
        "A_dft_seq_re": _A_in["dft_seq_re"],
        "A_dft_seq_im": _A_in["dft_seq_im"],
        "A_dft_hid_re": _A_in["dft_hid_re"],
        "A_dft_hid_im": _A_in["dft_hid_im"],
        "B_x": _B_in["x"],
        "B_wqkv": _B_in["wqkv"],
        "B_wo": _B_in["wo"],
    }

def reference(A_x, A_dft_seq_re, A_dft_seq_im, A_dft_hid_re, A_dft_hid_im, B_x, B_wqkv, B_wo):
    def _A_ref(x, dft_seq_re, dft_seq_im, dft_hid_re, dft_hid_im):
        a = torch.einsum("bsd,ed->bse", x, dft_hid_re)
        b = torch.einsum("bsd,ed->bse", x, dft_hid_im)
        y = torch.einsum("ts,bse->bte", dft_seq_re, a) - torch.einsum("ts,bse->bte", dft_seq_im, b)
        return y

    def _B_ref(x, wqkv, wo):
        B, S, D = x.shape
        H = 32; Dh = D // H
        qkv = (lambda x, *d: x.permute(*d))((x @ wqkv).reshape(B, S, 3, H, Dh), 2, 0, 3, 1, 4)
        q, k, v = qkv[0], qkv[1], qkv[2]
        scale = Dh ** -0.5
        scores = torch.einsum("bhqd,bhkd->bhqk", q, k) * scale
        p = _softmax(scores, axis=-1)
        o = torch.einsum("bhqk,bhkd->bhqd", p, v)
        return (lambda x, *d: x.permute(*d))(o, 0, 2, 1, 3).reshape(B, S, D) @ wo

    a = _A_ref(A_x, A_dft_seq_re, A_dft_seq_im, A_dft_hid_re, A_dft_hid_im)
    b = _B_ref(B_x, B_wqkv, B_wo)
    return torch.concatenate([a, b], axis=-1)
```

```asm
; @launch grid=(256,1,1) block=(512,1,1) lds=163840
.amdgcn_target "amdgcn-amd-amdhsa--gfx950"
.text
.globl concat_heads__spectral_fnet__softmax_full_mha__prompt_kernel
.p2align 8
.type concat_heads__spectral_fnet__softmax_full_mha__prompt_kernel,@function
concat_heads__spectral_fnet__softmax_full_mha__prompt_kernel:
  s_cmp_lt_u32 s2, 256
  s_cbranch_scc0 .Lexit
  s_load_dwordx16 s[8:23], s[0:1], 0
  s_load_dwordx4 s[24:27], s[0:1], 64
  s_load_dwordx2 s[28:29], s[0:1], 80
  v_lshrrev_b32 v1, 6, v0
  v_and_b32 v0, 63, v0
  v_readfirstlane_b32 s3, v1
  s_and_b32 s68, s2, 7
  s_lshr_b32 s69, s2, 3
  s_and_b32 s70, s68, 3
  s_lshl_b32 s70, s70, 2
  s_and_b32 s71, s69, 3
  s_add_u32 s90, s70, s71
  s_lshr_b32 s70, s68, 2
  s_mul_i32 s70, s70, 7
  s_lshr_b32 s72, s69, 2
  s_add_u32 s91, s70, s72
  s_lshl_b32 s71, s71, 1
  s_add_u32 s99, s71, s72
  s_sub_u32 s70, s99, 9
  s_cmp_ge_u32 s99, 9
  s_cselect_b32 s99, s70, s99
  s_mov_b32 s92, s69
  s_cmp_ge_u32 s69, 28
  s_cselect_b32 s93, 3, 0
  s_cmp_lt_u32 s3, 4
  s_cbranch_scc1 .Lcompute
  s_sub_u32 s70, s3, 4
  s_lshl_b32 s71, s70, 12
  v_and_b32 v4, 7, v0
  v_lshrrev_b32 v6, 4, v0
  v_xor_b32 v4, v4, v6
  v_xor_b32 v5, 4, v4
  v_lshlrev_b32 v4, 4, v4
  v_lshlrev_b32 v5, 4, v5
  s_lshl_b32 s79, s90, 7
  s_lshl_b32 s80, s70, 5
  s_add_u32 s79, s79, s80
  v_lshrrev_b32 v7, 3, v0
  v_add_u32 v7, s79, v7
  v_mul_u32_u24 v7, 1152, v7
  v_add_u32 v32, 0, v7
  v_add_u32 v32, v32, v4
  v_add_u32 v33, 8192, v7
  v_add_u32 v33, v33, v5
  v_add_u32 v34, 16384, v7
  v_add_u32 v34, v34, v4
  v_add_u32 v35, 24576, v7
  v_add_u32 v35, v35, v5
  v_lshlrev_b32 v7, 2, v6
  v_and_b32 v8, 15, v0
  v_xor_b32 v7, v7, v8
  v_lshlrev_b32 v7, 4, v7
  s_lshl_b32 s79, s70, 4
  v_add_u32 v6, s79, v6
  v_mul_u32_u24 v6, 3456, v6
  v_add_u32 v6, v6, v7
  s_lshl_b32 s79, s91, 8
  v_add_u32 v6, s79, v6
  v_add_u32 v36, 0, v6
  v_add_u32 v37, 12800, v6
  v_add_u32 v38, 25600, v6
  v_add_u32 v39, 38400, v6
  s_mov_b32 s75, s99
  s_mov_b32 s77, s99
  s_lshr_b32 s72, s71, 1
  s_mov_b32 s78, 0
  s_waitcnt lgkmcnt(0)
  s_cmp_lg_u32 s93, 0
  s_cbranch_scc1 .Ll_spare
  s_mov_b32 s32, s18
  s_mov_b32 s33, s19
  s_mov_b32 s34, 2359296
  s_mov_b32 s35, 0x20000
  s_mov_b32 s36, s20
  s_mov_b32 s37, s21
  s_mov_b32 s38, 1990656
  s_mov_b32 s39, 0x20000
  s_lshl_b32 s73, s75, 7
  s_add_u32 m0, s71, 0
  s_mul_i32 s74, s75, 221184
  buffer_load_dwordx4 v32, s[32:35], s73 offen offset:0 lds
  buffer_load_dwordx4 v33, s[32:35], s73 offen offset:1024 lds
  buffer_load_dwordx4 v34, s[32:35], s73 offen offset:2048 lds
  buffer_load_dwordx4 v35, s[32:35], s73 offen offset:3072 lds
  s_add_u32 s75, s75, 1
  s_add_u32 m0, s71, 16384
  s_cmp_eq_u32 s75, 9
  buffer_load_dwordx4 v36, s[36:39], s74 offen offset:0 lds
  buffer_load_dwordx4 v37, s[36:39], s74 offen offset:1024 lds
  buffer_load_dwordx4 v38, s[36:39], s74 offen offset:2048 lds
  buffer_load_dwordx4 v39, s[36:39], s74 offen offset:3072 lds
  s_cselect_b32 s75, 0, s75
  s_lshl_b32 s73, s75, 7
  s_add_u32 m0, s71, 32768
  s_mul_i32 s74, s75, 221184
  buffer_load_dwordx4 v32, s[32:35], s73 offen offset:0 lds
  buffer_load_dwordx4 v33, s[32:35], s73 offen offset:1024 lds
  buffer_load_dwordx4 v34, s[32:35], s73 offen offset:2048 lds
  buffer_load_dwordx4 v35, s[32:35], s73 offen offset:3072 lds
  s_add_u32 s75, s75, 1
  s_add_u32 m0, s71, 49152
  s_cmp_eq_u32 s75, 9
  buffer_load_dwordx4 v36, s[36:39], s74 offen offset:0 lds
  buffer_load_dwordx4 v37, s[36:39], s74 offen offset:1024 lds
  buffer_load_dwordx4 v38, s[36:39], s74 offen offset:2048 lds
  buffer_load_dwordx4 v39, s[36:39], s74 offen offset:3072 lds
  s_cselect_b32 s75, 0, s75
  s_mov_b32 s4, s28
  s_mov_b32 s5, s29
  s_mov_b32 s6, 268435456
  s_mov_b32 s7, 0x20000
  s_mov_b32 s64, s24
  s_mov_b32 s65, s25
  s_mov_b32 s66, 4718592
  s_mov_b32 s67, 0x20000
  s_mov_b32 s60, s22
  s_mov_b32 s61, s23
  s_mov_b32 s62, 663552
  s_mov_b32 s63, 0x20000
  s_mov_b32 s40, s8
  s_mov_b32 s41, s9
  s_mov_b32 s42, 2359296
  s_mov_b32 s43, 0x20000
  s_mov_b32 s52, s10
  s_mov_b32 s53, s11
  s_mov_b32 s54, 8388608
  s_mov_b32 s55, 0x20000
  s_mov_b32 s56, s12
  s_mov_b32 s57, s13
  s_mov_b32 s58, 8388608
  s_mov_b32 s59, 0x20000
  s_lshl_b32 s94, s68, 2
  s_lshr_b32 s95, s69, 3
  s_add_u32 s94, s94, s95
  s_and_b32 s95, s69, 7
  s_lshr_b32 s96, s3, 2
  s_and_b32 s97, s3, 3
  s_mov_b32 s98, 0
  v_lshrrev_b32 v6, 3, v0
  v_lshlrev_b32 v6, 7, v6
  v_and_b32 v7, 2, v0
  v_lshlrev_b32 v7, 5, v7
  v_and_b32 v8, 4, v0
  v_lshl_add_u32 v7, v8, 3, v7
  v_and_b32 v8, 1, v0
  v_lshl_add_u32 v7, v8, 4, v7
  v_add_u32 v251, v6, v7
  s_and_b32 s79, s3, 1
  s_lshl_b32 s79, s79, 7
  v_xor_b32 v250, s79, v251
  v_and_b32 v7, 4, v0
  v_lshlrev_b32 v7, 4, v7
  v_and_b32 v8, 1, v0
  v_lshl_add_u32 v7, v8, 5, v7
  v_and_b32 v8, 2, v0
  v_lshl_add_u32 v7, v8, 3, v7
  v_add_u32 v252, v6, v7
  s_add_u32 s80, s92, 0
  s_and_b32 s79, s80, 3
  s_lshl_b32 s81, s68, 2
  s_add_u32 s79, s79, s81
  s_lshr_b32 s80, s80, 2
  v_lshrrev_b32 v6, 3, v0
  v_lshrrev_b32 v7, 2, v6
  v_and_b32 v8, 3, v6
  v_lshl_add_u32 v8, v7, 3, v8
  s_and_b32 s81, s70, 1
  s_lshl_b32 s81, s81, 8
  s_lshr_b32 s82, s70, 1
  s_add_u32 s81, s81, s82
  s_lshl_b32 s82, s79, 1
  s_add_u32 s81, s81, s82
  v_lshlrev_b32 v8, 6, v8
  v_add_u32 v8, s81, v8
  v_mul_u32_u24 v8, 1152, v8
  v_add_u32 v40, v8, v4
  v_add_u32 v41, 1178624, v8
  v_add_u32 v41, v41, v5
  s_lshl_b32 s81, s80, 5
  s_lshl_b32 s82, s70, 3
  s_add_u32 s81, s81, s82
  v_and_b32 v8, 7, v0
  v_add_u32 v42, s81, v8
  s_lshl_b32 s81, s70, 4
  v_add_u32 v8, s81, v6
  v_mul_u32_u24 v8, 40960, v8
  v_and_b32 v7, 7, v0
  v_lshl_add_u32 v8, v7, 4, v8
  s_mul_i32 s81, s79, 1280
  s_lshl_b32 s82, s80, 7
  s_add_u32 s81, s81, s82
  s_add_u32 s81, s81, 7340032
  v_add_u32 v52, s81, v8
  v_and_b32 v6, 15, v0
  v_lshrrev_b32 v7, 1, v6
  v_lshrrev_b32 v8, 4, v0
  v_xor_b32 v7, v7, v8
  v_lshlrev_b32 v6, 7, v6
  v_lshl_add_u32 v60, v7, 4, v6
  v_xor_b32 v61, 64, v60
  v_add_u32 v62, 131072, v60
  v_add_u32 v63, 131072, v61
  v_add_u32 v60, 40960, v60
  v_add_u32 v61, 40960, v61
  v_mov_b32 v56, 162816
  v_mov_b32 v57, 1
  v_bfe_u32 v6, v0, 3, 1
  v_mul_u32_u24 v55, 0x8000, v6
  v_lshl_or_b32 v55, v55, 16, v55
  v_lshlrev_b32 v6, 12, v6
  v_lshl_add_u32 v6, v8, 9, v6
  v_and_b32 v7, 7, v0
  v_lshl_add_u32 v6, v7, 2, v6
  s_lshl_b32 s79, s70, 5
  s_add_u32 s79, s79, 98304
  v_add_u32 v53, s79, v6
  s_add_u32 s79, s72, 98304
  v_lshlrev_b32 v6, 4, v0
  v_add_u32 v59, s79, v6
  v_cvt_f32_u32 v43, v42
  v_and_b32 v6, 1, v42
  v_lshlrev_b32 v6, 1, v6
  v_bfe_u32 v7, v0, 3, 1
  v_add_u32 v6, v6, v7
  v_cvt_f32_u32 v6, v6
  v_mul_f32 v43, 987991609, v43
  v_mul_f32 v6, 0x3e800000, v6
  v_lshrrev_b32 v7, 4, v0
  v_lshlrev_b32 v7, 3, v7
  v_subrev_u32 v7, 288, v7
  v_cvt_f32_i32 v7, v7
  v_fma_f32 v44, v7, v43, v6
  s_mov_b32 s77, s99
  s_lshl_b32 s76, s77, 6
  v_cvt_f32_u32 v45, s76
  s_add_u32 s77, s77, 1
  s_cmp_eq_u32 s77, 9
  s_cselect_b32 s77, 0, s77
  v_fma_f32 v45, v45, v43, v44
  v_fmamk_f32 v47, v43, 1065353216, v45
  v_fmamk_f32 v48, v43, 1073741824, v45
  v_fmamk_f32 v49, v43, 1077936128, v45
  v_fmamk_f32 v50, v43, 1082130432, v45
  v_fmamk_f32 v51, v43, 1084227584, v45
  v_fmamk_f32 v8, v43, 1086324736, v45
  v_fmamk_f32 v9, v43, 1088421888, v45
  v_cos_f32 v46, v45
  v_cos_f32 v47, v47
  v_cos_f32 v48, v48
  v_cos_f32 v49, v49
  v_cos_f32 v50, v50
  v_cos_f32 v51, v51
  v_cos_f32 v8, v8
  v_cos_f32 v9, v9
  v_cvt_pk_bf16_f32 v128, v46, v47
  v_cvt_pk_bf16_f32 v129, v48, v49
  v_cvt_pk_bf16_f32 v130, v50, v51
  v_cvt_pk_bf16_f32 v131, v8, v9
  v_fmamk_f32 v46, v43, 1107296256, v45
  v_fmamk_f32 v47, v43, 1107558400, v45
  v_fmamk_f32 v48, v43, 1107820544, v45
  v_fmamk_f32 v49, v43, 1108082688, v45
  v_fmamk_f32 v50, v43, 1108344832, v45
  v_fmamk_f32 v51, v43, 1108606976, v45
  v_fmamk_f32 v8, v43, 1108869120, v45
  v_fmamk_f32 v9, v43, 1109131264, v45
  v_cos_f32 v46, v46
  v_cos_f32 v47, v47
  v_cos_f32 v48, v48
  v_cos_f32 v49, v49
  v_cos_f32 v50, v50
  v_cos_f32 v51, v51
  v_cos_f32 v8, v8
  v_cos_f32 v9, v9
  v_cvt_pk_bf16_f32 v132, v46, v47
  v_cvt_pk_bf16_f32 v133, v48, v49
  v_cvt_pk_bf16_f32 v134, v50, v51
  v_cvt_pk_bf16_f32 v135, v8, v9
  s_waitcnt vmcnt(8)
  s_barrier
  s_lshl_b32 s73, s75, 7
  s_add_u32 m0, s71, 65536
  s_mul_i32 s74, s75, 221184
  buffer_load_dwordx4 v32, s[32:35], s73 offen offset:0 lds
  buffer_load_dwordx4 v33, s[32:35], s73 offen offset:1024 lds
  buffer_load_dwordx4 v34, s[32:35], s73 offen offset:2048 lds
  buffer_load_dwordx4 v35, s[32:35], s73 offen offset:3072 lds
  s_add_u32 s75, s75, 1
  s_add_u32 m0, s71, 81920
  s_cmp_eq_u32 s75, 9
  buffer_load_dwordx4 v36, s[36:39], s74 offen offset:0 lds
  buffer_load_dwordx4 v37, s[36:39], s74 offen offset:1024 lds
  buffer_load_dwordx4 v38, s[36:39], s74 offen offset:2048 lds
  buffer_load_dwordx4 v39, s[36:39], s74 offen offset:3072 lds
  s_cselect_b32 s75, 0, s75
  s_lshl_b32 s76, s77, 6
  v_cvt_f32_u32 v45, s76
  s_add_u32 s77, s77, 1
  s_cmp_eq_u32 s77, 9
  s_cselect_b32 s77, 0, s77
  v_fma_f32 v45, v45, v43, v44
  v_fmamk_f32 v47, v43, 1065353216, v45
  v_fmamk_f32 v48, v43, 1073741824, v45
  v_fmamk_f32 v49, v43, 1077936128, v45
  v_fmamk_f32 v50, v43, 1082130432, v45
  v_fmamk_f32 v51, v43, 1084227584, v45
  v_fmamk_f32 v8, v43, 1086324736, v45
  v_fmamk_f32 v9, v43, 1088421888, v45
  v_cos_f32 v46, v45
  v_cos_f32 v47, v47
  v_cos_f32 v48, v48
  v_cos_f32 v49, v49
  v_cos_f32 v50, v50
  v_cos_f32 v51, v51
  v_cos_f32 v8, v8
  v_cos_f32 v9, v9
  v_cvt_pk_bf16_f32 v136, v46, v47
  v_cvt_pk_bf16_f32 v137, v48, v49
  v_cvt_pk_bf16_f32 v138, v50, v51
  v_cvt_pk_bf16_f32 v139, v8, v9
  v_fmamk_f32 v46, v43, 1107296256, v45
  v_fmamk_f32 v47, v43, 1107558400, v45
  v_fmamk_f32 v48, v43, 1107820544, v45
  v_fmamk_f32 v49, v43, 1108082688, v45
  v_fmamk_f32 v50, v43, 1108344832, v45
  v_fmamk_f32 v51, v43, 1108606976, v45
  v_fmamk_f32 v8, v43, 1108869120, v45
  v_fmamk_f32 v9, v43, 1109131264, v45
  v_cos_f32 v46, v46
  v_cos_f32 v47, v47
  v_cos_f32 v48, v48
  v_cos_f32 v49, v49
  v_cos_f32 v50, v50
  v_cos_f32 v51, v51
  v_cos_f32 v8, v8
  v_cos_f32 v9, v9
  v_cvt_pk_bf16_f32 v140, v46, v47
  v_cvt_pk_bf16_f32 v141, v48, v49
  v_cvt_pk_bf16_f32 v142, v50, v51
  v_cvt_pk_bf16_f32 v143, v8, v9
  s_waitcnt vmcnt(8)
  s_barrier
  s_lshl_b32 s73, s75, 7
  s_add_u32 m0, s71, 98304
  s_mul_i32 s74, s75, 221184
  buffer_load_dwordx4 v32, s[32:35], s73 offen offset:0 lds
  buffer_load_dwordx4 v33, s[32:35], s73 offen offset:1024 lds
  buffer_load_dwordx4 v34, s[32:35], s73 offen offset:2048 lds
  buffer_load_dwordx4 v35, s[32:35], s73 offen offset:3072 lds
  s_add_u32 s75, s75, 1
  s_add_u32 m0, s71, 114688
  s_cmp_eq_u32 s75, 9
  buffer_load_dwordx4 v36, s[36:39], s74 offen offset:0 lds
  buffer_load_dwordx4 v37, s[36:39], s74 offen offset:1024 lds
  buffer_load_dwordx4 v38, s[36:39], s74 offen offset:2048 lds
  buffer_load_dwordx4 v39, s[36:39], s74 offen offset:3072 lds
  s_cselect_b32 s75, 0, s75
  s_lshl_b32 s76, s77, 6
  v_cvt_f32_u32 v45, s76
  s_add_u32 s77, s77, 1
  s_cmp_eq_u32 s77, 9
  s_cselect_b32 s77, 0, s77
  v_fma_f32 v45, v45, v43, v44
  v_fmamk_f32 v47, v43, 1065353216, v45
  v_fmamk_f32 v48, v43, 1073741824, v45
  v_fmamk_f32 v49, v43, 1077936128, v45
  v_fmamk_f32 v50, v43, 1082130432, v45
  v_fmamk_f32 v51, v43, 1084227584, v45
  v_fmamk_f32 v8, v43, 1086324736, v45
  v_fmamk_f32 v9, v43, 1088421888, v45
  v_cos_f32 v46, v45
  v_cos_f32 v47, v47
  v_cos_f32 v48, v48
  v_cos_f32 v49, v49
  v_cos_f32 v50, v50
  v_cos_f32 v51, v51
  v_cos_f32 v8, v8
  v_cos_f32 v9, v9
  v_cvt_pk_bf16_f32 v144, v46, v47
  v_cvt_pk_bf16_f32 v145, v48, v49
  v_cvt_pk_bf16_f32 v146, v50, v51
  v_cvt_pk_bf16_f32 v147, v8, v9
  v_fmamk_f32 v46, v43, 1107296256, v45
  v_fmamk_f32 v47, v43, 1107558400, v45
  v_fmamk_f32 v48, v43, 1107820544, v45
  v_fmamk_f32 v49, v43, 1108082688, v45
  v_fmamk_f32 v50, v43, 1108344832, v45
  v_fmamk_f32 v51, v43, 1108606976, v45
  v_fmamk_f32 v8, v43, 1108869120, v45
  v_fmamk_f32 v9, v43, 1109131264, v45
  v_cos_f32 v46, v46
  v_cos_f32 v47, v47
  v_cos_f32 v48, v48
  v_cos_f32 v49, v49
  v_cos_f32 v50, v50
  v_cos_f32 v51, v51
  v_cos_f32 v8, v8
  v_cos_f32 v9, v9
  v_cvt_pk_bf16_f32 v148, v46, v47
  v_cvt_pk_bf16_f32 v149, v48, v49
  v_cvt_pk_bf16_f32 v150, v50, v51
  v_cvt_pk_bf16_f32 v151, v8, v9
  s_waitcnt vmcnt(8)
  s_barrier
  s_lshl_b32 s73, s75, 7
  s_add_u32 m0, s71, 0
  s_mul_i32 s74, s75, 221184
  buffer_load_dwordx4 v32, s[32:35], s73 offen offset:0 lds
  buffer_load_dwordx4 v33, s[32:35], s73 offen offset:1024 lds
  buffer_load_dwordx4 v34, s[32:35], s73 offen offset:2048 lds
  buffer_load_dwordx4 v35, s[32:35], s73 offen offset:3072 lds
  s_add_u32 s75, s75, 1
  s_add_u32 m0, s71, 16384
  s_cmp_eq_u32 s75, 9
  buffer_load_dwordx4 v36, s[36:39], s74 offen offset:0 lds
  buffer_load_dwordx4 v37, s[36:39], s74 offen offset:1024 lds
  buffer_load_dwordx4 v38, s[36:39], s74 offen offset:2048 lds
  buffer_load_dwordx4 v39, s[36:39], s74 offen offset:3072 lds
  s_cselect_b32 s75, 0, s75
  s_lshl_b32 s76, s77, 6
  v_cvt_f32_u32 v45, s76
  s_add_u32 s77, s77, 1
  s_cmp_eq_u32 s77, 9
  s_cselect_b32 s77, 0, s77
  v_fma_f32 v45, v45, v43, v44
  v_fmamk_f32 v47, v43, 1065353216, v45
  v_fmamk_f32 v48, v43, 1073741824, v45
  v_fmamk_f32 v49, v43, 1077936128, v45
  v_fmamk_f32 v50, v43, 1082130432, v45
  v_fmamk_f32 v51, v43, 1084227584, v45
  v_fmamk_f32 v8, v43, 1086324736, v45
  v_fmamk_f32 v9, v43, 1088421888, v45
  v_cos_f32 v46, v45
  v_cos_f32 v47, v47
  v_cos_f32 v48, v48
  v_cos_f32 v49, v49
  v_cos_f32 v50, v50
  v_cos_f32 v51, v51
  v_cos_f32 v8, v8
  v_cos_f32 v9, v9
  v_cvt_pk_bf16_f32 v152, v46, v47
  v_cvt_pk_bf16_f32 v153, v48, v49
  v_cvt_pk_bf16_f32 v154, v50, v51
  v_cvt_pk_bf16_f32 v155, v8, v9
  v_fmamk_f32 v46, v43, 1107296256, v45
  v_fmamk_f32 v47, v43, 1107558400, v45
  v_fmamk_f32 v48, v43, 1107820544, v45
  v_fmamk_f32 v49, v43, 1108082688, v45
  v_fmamk_f32 v50, v43, 1108344832, v45
  v_fmamk_f32 v51, v43, 1108606976, v45
  v_fmamk_f32 v8, v43, 1108869120, v45
  v_fmamk_f32 v9, v43, 1109131264, v45
  v_cos_f32 v46, v46
  v_cos_f32 v47, v47
  v_cos_f32 v48, v48
  v_cos_f32 v49, v49
  v_cos_f32 v50, v50
  v_cos_f32 v51, v51
  v_cos_f32 v8, v8
  v_cos_f32 v9, v9
  v_cvt_pk_bf16_f32 v156, v46, v47
  v_cvt_pk_bf16_f32 v157, v48, v49
  v_cvt_pk_bf16_f32 v158, v50, v51
  v_cvt_pk_bf16_f32 v159, v8, v9
  s_waitcnt vmcnt(8)
  s_barrier
  s_lshl_b32 s73, s75, 7
  s_add_u32 m0, s71, 32768
  s_mul_i32 s74, s75, 221184
  buffer_load_dwordx4 v32, s[32:35], s73 offen offset:0 lds
  buffer_load_dwordx4 v33, s[32:35], s73 offen offset:1024 lds
  buffer_load_dwordx4 v34, s[32:35], s73 offen offset:2048 lds
  buffer_load_dwordx4 v35, s[32:35], s73 offen offset:3072 lds
  s_add_u32 s75, s75, 1
  s_add_u32 m0, s71, 49152
  s_cmp_eq_u32 s75, 9
  buffer_load_dwordx4 v36, s[36:39], s74 offen offset:0 lds
  buffer_load_dwordx4 v37, s[36:39], s74 offen offset:1024 lds
  buffer_load_dwordx4 v38, s[36:39], s74 offen offset:2048 lds
  buffer_load_dwordx4 v39, s[36:39], s74 offen offset:3072 lds
  s_cselect_b32 s75, 0, s75
  s_lshl_b32 s76, s77, 6
  v_cvt_f32_u32 v45, s76
  s_add_u32 s77, s77, 1
  s_cmp_eq_u32 s77, 9
  s_cselect_b32 s77, 0, s77
  v_fma_f32 v45, v45, v43, v44
  v_fmamk_f32 v47, v43, 1065353216, v45
  v_fmamk_f32 v48, v43, 1073741824, v45
  v_fmamk_f32 v49, v43, 1077936128, v45
  v_fmamk_f32 v50, v43, 1082130432, v45
  v_fmamk_f32 v51, v43, 1084227584, v45
  v_fmamk_f32 v8, v43, 1086324736, v45
  v_fmamk_f32 v9, v43, 1088421888, v45
  v_cos_f32 v46, v45
  v_cos_f32 v47, v47
  v_cos_f32 v48, v48
  v_cos_f32 v49, v49
  v_cos_f32 v50, v50
  v_cos_f32 v51, v51
  v_cos_f32 v8, v8
  v_cos_f32 v9, v9
  v_cvt_pk_bf16_f32 v160, v46, v47
  v_cvt_pk_bf16_f32 v161, v48, v49
  v_cvt_pk_bf16_f32 v162, v50, v51
  v_cvt_pk_bf16_f32 v163, v8, v9
  v_fmamk_f32 v46, v43, 1107296256, v45
  v_fmamk_f32 v47, v43, 1107558400, v45
  v_fmamk_f32 v48, v43, 1107820544, v45
  v_fmamk_f32 v49, v43, 1108082688, v45
  v_fmamk_f32 v50, v43, 1108344832, v45
  v_fmamk_f32 v51, v43, 1108606976, v45
  v_fmamk_f32 v8, v43, 1108869120, v45
  v_fmamk_f32 v9, v43, 1109131264, v45
  v_cos_f32 v46, v46
  v_cos_f32 v47, v47
  v_cos_f32 v48, v48
  v_cos_f32 v49, v49
  v_cos_f32 v50, v50
  v_cos_f32 v51, v51
  v_cos_f32 v8, v8
  v_cos_f32 v9, v9
  v_cvt_pk_bf16_f32 v164, v46, v47
  v_cvt_pk_bf16_f32 v165, v48, v49
  v_cvt_pk_bf16_f32 v166, v50, v51
  v_cvt_pk_bf16_f32 v167, v8, v9
  s_waitcnt vmcnt(8)
  s_barrier
  s_lshl_b32 s73, s75, 7
  s_add_u32 m0, s71, 65536
  s_mul_i32 s74, s75, 221184
  buffer_load_dwordx4 v32, s[32:35], s73 offen offset:0 lds
  buffer_load_dwordx4 v33, s[32:35], s73 offen offset:1024 lds
  buffer_load_dwordx4 v34, s[32:35], s73 offen offset:2048 lds
  buffer_load_dwordx4 v35, s[32:35], s73 offen offset:3072 lds
  s_add_u32 s75, s75, 1
  s_add_u32 m0, s71, 81920
  s_cmp_eq_u32 s75, 9
  buffer_load_dwordx4 v36, s[36:39], s74 offen offset:0 lds
  buffer_load_dwordx4 v37, s[36:39], s74 offen offset:1024 lds
  buffer_load_dwordx4 v38, s[36:39], s74 offen offset:2048 lds
  buffer_load_dwordx4 v39, s[36:39], s74 offen offset:3072 lds
  s_cselect_b32 s75, 0, s75
  s_lshl_b32 s76, s77, 6
  v_cvt_f32_u32 v45, s76
  s_add_u32 s77, s77, 1
  s_cmp_eq_u32 s77, 9
  s_cselect_b32 s77, 0, s77
  v_fma_f32 v45, v45, v43, v44
  v_fmamk_f32 v47, v43, 1065353216, v45
  v_fmamk_f32 v48, v43, 1073741824, v45
  v_fmamk_f32 v49, v43, 1077936128, v45
  v_fmamk_f32 v50, v43, 1082130432, v45
  v_fmamk_f32 v51, v43, 1084227584, v45
  v_fmamk_f32 v8, v43, 1086324736, v45
  v_fmamk_f32 v9, v43, 1088421888, v45
  v_cos_f32 v46, v45
  v_cos_f32 v47, v47
  v_cos_f32 v48, v48
  v_cos_f32 v49, v49
  v_cos_f32 v50, v50
  v_cos_f32 v51, v51
  v_cos_f32 v8, v8
  v_cos_f32 v9, v9
  v_cvt_pk_bf16_f32 v168, v46, v47
  v_cvt_pk_bf16_f32 v169, v48, v49
  v_cvt_pk_bf16_f32 v170, v50, v51
  v_cvt_pk_bf16_f32 v171, v8, v9
  v_fmamk_f32 v46, v43, 1107296256, v45
  v_fmamk_f32 v47, v43, 1107558400, v45
  v_fmamk_f32 v48, v43, 1107820544, v45
  v_fmamk_f32 v49, v43, 1108082688, v45
  v_fmamk_f32 v50, v43, 1108344832, v45
  v_fmamk_f32 v51, v43, 1108606976, v45
  v_fmamk_f32 v8, v43, 1108869120, v45
  v_fmamk_f32 v9, v43, 1109131264, v45
  v_cos_f32 v46, v46
  v_cos_f32 v47, v47
  v_cos_f32 v48, v48
  v_cos_f32 v49, v49
  v_cos_f32 v50, v50
  v_cos_f32 v51, v51
  v_cos_f32 v8, v8
  v_cos_f32 v9, v9
  v_cvt_pk_bf16_f32 v172, v46, v47
  v_cvt_pk_bf16_f32 v173, v48, v49
  v_cvt_pk_bf16_f32 v174, v50, v51
  v_cvt_pk_bf16_f32 v175, v8, v9
  s_waitcnt vmcnt(8)
  s_barrier
  s_lshl_b32 s73, s75, 7
  s_add_u32 m0, s71, 98304
  s_mul_i32 s74, s75, 221184
  buffer_load_dwordx4 v32, s[32:35], s73 offen offset:0 lds
  buffer_load_dwordx4 v33, s[32:35], s73 offen offset:1024 lds
  buffer_load_dwordx4 v34, s[32:35], s73 offen offset:2048 lds
  buffer_load_dwordx4 v35, s[32:35], s73 offen offset:3072 lds
  s_add_u32 s75, s75, 1
  s_add_u32 m0, s71, 114688
  s_cmp_eq_u32 s75, 9
  buffer_load_dwordx4 v36, s[36:39], s74 offen offset:0 lds
  buffer_load_dwordx4 v37, s[36:39], s74 offen offset:1024 lds
  buffer_load_dwordx4 v38, s[36:39], s74 offen offset:2048 lds
  buffer_load_dwordx4 v39, s[36:39], s74 offen offset:3072 lds
  s_cselect_b32 s75, 0, s75
  s_lshl_b32 s76, s77, 6
  v_cvt_f32_u32 v45, s76
  s_add_u32 s77, s77, 1
  s_cmp_eq_u32 s77, 9
  s_cselect_b32 s77, 0, s77
  v_fma_f32 v45, v45, v43, v44
  v_fmamk_f32 v47, v43, 1065353216, v45
  v_fmamk_f32 v48, v43, 1073741824, v45
  v_fmamk_f32 v49, v43, 1077936128, v45
  v_fmamk_f32 v50, v43, 1082130432, v45
  v_fmamk_f32 v51, v43, 1084227584, v45
  v_fmamk_f32 v8, v43, 1086324736, v45
  v_fmamk_f32 v9, v43, 1088421888, v45
  v_cos_f32 v46, v45
  v_cos_f32 v47, v47
  v_cos_f32 v48, v48
  v_cos_f32 v49, v49
  v_cos_f32 v50, v50
  v_cos_f32 v51, v51
  v_cos_f32 v8, v8
  v_cos_f32 v9, v9
  v_cvt_pk_bf16_f32 v176, v46, v47
  v_cvt_pk_bf16_f32 v177, v48, v49
  v_cvt_pk_bf16_f32 v178, v50, v51
  v_cvt_pk_bf16_f32 v179, v8, v9
  v_fmamk_f32 v46, v43, 1107296256, v45
  v_fmamk_f32 v47, v43, 1107558400, v45
  v_fmamk_f32 v48, v43, 1107820544, v45
  v_fmamk_f32 v49, v43, 1108082688, v45
  v_fmamk_f32 v50, v43, 1108344832, v45
  v_fmamk_f32 v51, v43, 1108606976, v45
  v_fmamk_f32 v8, v43, 1108869120, v45
  v_fmamk_f32 v9, v43, 1109131264, v45
  v_cos_f32 v46, v46
  v_cos_f32 v47, v47
  v_cos_f32 v48, v48
  v_cos_f32 v49, v49
  v_cos_f32 v50, v50
  v_cos_f32 v51, v51
  v_cos_f32 v8, v8
  v_cos_f32 v9, v9
  v_cvt_pk_bf16_f32 v180, v46, v47
  v_cvt_pk_bf16_f32 v181, v48, v49
  v_cvt_pk_bf16_f32 v182, v50, v51
  v_cvt_pk_bf16_f32 v183, v8, v9
  s_waitcnt vmcnt(8)
  s_barrier
  s_lshl_b32 s73, s75, 7
  s_add_u32 m0, s71, 0
  s_mul_i32 s74, s75, 221184
  buffer_load_dwordx4 v32, s[32:35], s73 offen offset:0 lds
  buffer_load_dwordx4 v33, s[32:35], s73 offen offset:1024 lds
  buffer_load_dwordx4 v34, s[32:35], s73 offen offset:2048 lds
  buffer_load_dwordx4 v35, s[32:35], s73 offen offset:3072 lds
  s_add_u32 s75, s75, 1
  s_add_u32 m0, s71, 16384
  s_cmp_eq_u32 s75, 9
  buffer_load_dwordx4 v36, s[36:39], s74 offen offset:0 lds
  buffer_load_dwordx4 v37, s[36:39], s74 offen offset:1024 lds
  buffer_load_dwordx4 v38, s[36:39], s74 offen offset:2048 lds
  buffer_load_dwordx4 v39, s[36:39], s74 offen offset:3072 lds
  s_cselect_b32 s75, 0, s75
  s_lshl_b32 s73, s75, 7
  s_add_u32 m0, s72, 131072
  s_add_u32 s75, s75, 1
  buffer_load_dwordx4 v40, s[40:43], s73 offen lds
  s_cmp_eq_u32 s75, 9
  s_cselect_b32 s75, 0, s75
  buffer_load_dwordx4 v41, s[40:43], s73 offen offset:1024 lds
  s_lshl_b32 s76, s77, 6
  v_cvt_f32_u32 v45, s76
  s_add_u32 s77, s77, 1
  s_cmp_eq_u32 s77, 9
  s_cselect_b32 s77, 0, s77
  v_fma_f32 v45, v45, v43, v44
  v_fmamk_f32 v47, v43, 1065353216, v45
  v_fmamk_f32 v48, v43, 1073741824, v45
  v_fmamk_f32 v49, v43, 1077936128, v45
  v_fmamk_f32 v50, v43, 1082130432, v45
  v_fmamk_f32 v51, v43, 1084227584, v45
  v_fmamk_f32 v8, v43, 1086324736, v45
  v_fmamk_f32 v9, v43, 1088421888, v45
  v_cos_f32 v46, v45
  v_cos_f32 v47, v47
  v_cos_f32 v48, v48
  v_cos_f32 v49, v49
  v_cos_f32 v50, v50
  v_cos_f32 v51, v51
  v_cos_f32 v8, v8
  v_cos_f32 v9, v9
  v_cvt_pk_bf16_f32 v184, v46, v47
  v_cvt_pk_bf16_f32 v185, v48, v49
  v_cvt_pk_bf16_f32 v186, v50, v51
  v_cvt_pk_bf16_f32 v187, v8, v9
  v_fmamk_f32 v46, v43, 1107296256, v45
  v_fmamk_f32 v47, v43, 1107558400, v45
  v_fmamk_f32 v48, v43, 1107820544, v45
  v_fmamk_f32 v49, v43, 1108082688, v45
  v_fmamk_f32 v50, v43, 1108344832, v45
  v_fmamk_f32 v51, v43, 1108606976, v45
  v_fmamk_f32 v8, v43, 1108869120, v45
  v_fmamk_f32 v9, v43, 1109131264, v45
  v_cos_f32 v46, v46
  v_cos_f32 v47, v47
  v_cos_f32 v48, v48
  v_cos_f32 v49, v49
  v_cos_f32 v50, v50
  v_cos_f32 v51, v51
  v_cos_f32 v8, v8
  v_cos_f32 v9, v9
  v_cvt_pk_bf16_f32 v188, v46, v47
  v_cvt_pk_bf16_f32 v189, v48, v49
  v_cvt_pk_bf16_f32 v190, v50, v51
  v_cvt_pk_bf16_f32 v191, v8, v9
  s_waitcnt vmcnt(10)
  s_barrier
  s_lshl_b32 s73, s75, 7
  s_add_u32 m0, s72, 139264
  s_add_u32 s75, s75, 1
  buffer_load_dwordx4 v40, s[40:43], s73 offen lds
  s_cmp_eq_u32 s75, 9
  s_cselect_b32 s75, 0, s75
  buffer_load_dwordx4 v41, s[40:43], s73 offen offset:1024 lds
  v_and_b32 v2, 15, v0
  v_lshlrev_b32 v2, 18, v2
  v_lshrrev_b32 v3, 4, v0
  v_lshl_add_u32 v2, v3, 4, v2
  s_mov_b32 s79, 4194304
  buffer_load_dwordx4 v[16:19], v2, s[52:55], 0 offen
  buffer_load_dwordx4 v[20:23], v2, s[52:55], s79 offen
  buffer_load_dwordx4 v[24:27], v2, s[56:59], 0 offen
  buffer_load_dwordx4 v[28:31], v2, s[56:59], s79 offen
  s_lshl_b32 s73, s75, 7
  s_add_u32 m0, s72, 40960
  s_add_u32 s75, s75, 1
  buffer_load_dwordx4 v40, s[40:43], s73 offen lds
  s_cmp_eq_u32 s75, 9
  s_cselect_b32 s75, 0, s75
  buffer_load_dwordx4 v41, s[40:43], s73 offen offset:1024 lds
  s_lshl_b32 s76, s77, 6
  v_cvt_f32_u32 v45, s76
  s_add_u32 s77, s77, 1
  s_cmp_eq_u32 s77, 9
  s_cselect_b32 s77, 0, s77
  v_fma_f32 v45, v45, v43, v44
  v_fmamk_f32 v47, v43, 1065353216, v45
  v_fmamk_f32 v48, v43, 1073741824, v45
  v_fmamk_f32 v49, v43, 1077936128, v45
  v_fmamk_f32 v50, v43, 1082130432, v45
  v_fmamk_f32 v51, v43, 1084227584, v45
  v_fmamk_f32 v8, v43, 1086324736, v45
  v_fmamk_f32 v9, v43, 1088421888, v45
  v_cos_f32 v46, v45
  v_cos_f32 v47, v47
  v_cos_f32 v48, v48
  v_cos_f32 v49, v49
  v_cos_f32 v50, v50
  v_cos_f32 v51, v51
  v_cos_f32 v8, v8
  v_cos_f32 v9, v9
  v_cvt_pk_bf16_f32 v192, v46, v47
  v_cvt_pk_bf16_f32 v193, v48, v49
  v_cvt_pk_bf16_f32 v194, v50, v51
  v_cvt_pk_bf16_f32 v195, v8, v9
  v_fmamk_f32 v46, v43, 1107296256, v45
  v_fmamk_f32 v47, v43, 1107558400, v45
  v_fmamk_f32 v48, v43, 1107820544, v45
  v_fmamk_f32 v49, v43, 1108082688, v45
  v_fmamk_f32 v50, v43, 1108344832, v45
  v_fmamk_f32 v51, v43, 1108606976, v45
  v_fmamk_f32 v8, v43, 1108869120, v45
  v_fmamk_f32 v9, v43, 1109131264, v45
  v_cos_f32 v46, v46
  v_cos_f32 v47, v47
  v_cos_f32 v48, v48
  v_cos_f32 v49, v49
  v_cos_f32 v50, v50
  v_cos_f32 v51, v51
  v_cos_f32 v8, v8
  v_cos_f32 v9, v9
  v_cvt_pk_bf16_f32 v196, v46, v47
  v_cvt_pk_bf16_f32 v197, v48, v49
  v_cvt_pk_bf16_f32 v198, v50, v51
  v_cvt_pk_bf16_f32 v199, v8, v9
  s_waitcnt vmcnt(10)
  s_barrier
  s_lshl_b32 s73, s75, 7
  s_add_u32 m0, s72, 49152
  s_add_u32 s75, s75, 1
  buffer_load_dwordx4 v40, s[40:43], s73 offen lds
  s_cmp_eq_u32 s75, 9
  s_cselect_b32 s75, 0, s75
  buffer_load_dwordx4 v41, s[40:43], s73 offen offset:1024 lds
  s_lshl_b32 s73, s75, 7
  s_add_u32 m0, s72, 57344
  s_add_u32 s75, s75, 1
  buffer_load_dwordx4 v40, s[40:43], s73 offen lds
  s_cmp_eq_u32 s75, 9
  s_cselect_b32 s75, 0, s75
  buffer_load_dwordx4 v41, s[40:43], s73 offen offset:1024 lds
  s_barrier
  s_lshl_b32 s73, s75, 7
  s_add_u32 m0, s72, 65536
  s_add_u32 s75, s75, 1
  buffer_load_dwordx4 v40, s[40:43], s73 offen lds
  s_cmp_eq_u32 s75, 9
  s_cselect_b32 s75, 0, s75
  buffer_load_dwordx4 v41, s[40:43], s73 offen offset:1024 lds
  s_lshl_b32 s73, s75, 7
  s_add_u32 m0, s72, 73728
  s_add_u32 s75, s75, 1
  buffer_load_dwordx4 v40, s[40:43], s73 offen lds
  s_cmp_eq_u32 s75, 9
  s_cselect_b32 s75, 0, s75
  buffer_load_dwordx4 v41, s[40:43], s73 offen offset:1024 lds
  s_setprio 0
  s_barrier
  s_waitcnt vmcnt(8)
  s_mov_b64 exec, 1
  ds_add_u32 v56, v57
  s_mov_b64 exec, -1
  s_add_u32 s78, s78, 4
.Lfs_1:
  ds_read_b32 v58, v56
  s_waitcnt lgkmcnt(0)
  v_readfirstlane_b32 s79, v58
  s_cmp_lt_u32 s79, s78
  s_cbranch_scc1 .Lfs_1
  ds_read_b128 v[64:67], v62 offset:0
  ds_read_b128 v[68:71], v62 offset:2048
  ds_read_b128 v[72:75], v62 offset:4096
  ds_read_b128 v[76:79], v62 offset:6144
  ds_read_b128 v[80:83], v63 offset:0
  ds_read_b128 v[84:87], v63 offset:2048
  ds_read_b128 v[88:91], v63 offset:4096
  ds_read_b128 v[92:95], v63 offset:6144
  s_waitcnt lgkmcnt(7)
  ds_read_b128 v[96:99], v62 offset:8192
  ds_read_b128 v[100:103], v62 offset:10240
  ds_read_b128 v[104:107], v62 offset:12288
  ds_read_b128 v[108:111], v62 offset:14336
  ds_read_b128 v[112:115], v63 offset:8192
  ds_read_b128 v[116:119], v63 offset:10240
  ds_read_b128 v[120:123], v63 offset:12288
  ds_read_b128 v[124:127], v63 offset:14336
  s_waitcnt lgkmcnt(15)
  v_mfma_f32_16x16x32_bf16 v[200:203], v[64:67], v[128:131], 0
  s_waitcnt lgkmcnt(14)
  v_mfma_f32_16x16x32_bf16 v[204:207], v[68:71], v[128:131], 0
  s_waitcnt lgkmcnt(13)
  v_mfma_f32_16x16x32_bf16 v[208:211], v[72:75], v[128:131], 0
  s_waitcnt lgkmcnt(12)
  v_mfma_f32_16x16x32_bf16 v[212:215], v[76:79], v[128:131], 0
  s_waitcnt lgkmcnt(11)
  v_mfma_f32_16x16x32_bf16 v[200:203], v[80:83], v[132:135], v[200:203]
  s_waitcnt lgkmcnt(10)
  v_mfma_f32_16x16x32_bf16 v[204:207], v[84:87], v[132:135], v[204:207]
  s_waitcnt lgkmcnt(9)
  v_mfma_f32_16x16x32_bf16 v[208:211], v[88:91], v[132:135], v[208:211]
  s_waitcnt lgkmcnt(8)
  v_mfma_f32_16x16x32_bf16 v[212:215], v[92:95], v[132:135], v[212:215]
  s_waitcnt lgkmcnt(7)
  ds_read_b128 v[64:67], v60 offset:0
  ds_read_b128 v[68:71], v60 offset:2048
  ds_read_b128 v[72:75], v60 offset:4096
  ds_read_b128 v[76:79], v60 offset:6144
  ds_read_b128 v[80:83], v61 offset:0
  ds_read_b128 v[84:87], v61 offset:2048
  ds_read_b128 v[88:91], v61 offset:4096
  ds_read_b128 v[92:95], v61 offset:6144
  s_waitcnt lgkmcnt(15)
  v_mfma_f32_16x16x32_bf16 v[200:203], v[96:99], v[136:139], v[200:203]
  s_waitcnt lgkmcnt(14)
  v_mfma_f32_16x16x32_bf16 v[204:207], v[100:103], v[136:139], v[204:207]
  s_waitcnt lgkmcnt(13)
  v_mfma_f32_16x16x32_bf16 v[208:211], v[104:107], v[136:139], v[208:211]
  s_waitcnt lgkmcnt(12)
  v_mfma_f32_16x16x32_bf16 v[212:215], v[108:111], v[136:139], v[212:215]
  s_waitcnt lgkmcnt(11)
  v_mfma_f32_16x16x32_bf16 v[200:203], v[112:115], v[140:143], v[200:203]
  s_waitcnt lgkmcnt(10)
  v_mfma_f32_16x16x32_bf16 v[204:207], v[116:119], v[140:143], v[204:207]
  s_waitcnt lgkmcnt(9)
  v_mfma_f32_16x16x32_bf16 v[208:211], v[120:123], v[140:143], v[208:211]
  s_waitcnt lgkmcnt(8)
  v_mfma_f32_16x16x32_bf16 v[212:215], v[124:127], v[140:143], v[212:215]
  s_waitcnt lgkmcnt(7)
  v_mfma_f32_16x16x32_bf16 v[200:203], v[64:67], v[144:147], v[200:203]
  s_waitcnt lgkmcnt(6)
  v_mfma_f32_16x16x32_bf16 v[204:207], v[68:71], v[144:147], v[204:207]
  s_waitcnt lgkmcnt(5)
  v_mfma_f32_16x16x32_bf16 v[208:211], v[72:75], v[144:147], v[208:211]
  s_waitcnt lgkmcnt(4)
  v_mfma_f32_16x16x32_bf16 v[212:215], v[76:79], v[144:147], v[212:215]
  s_waitcnt lgkmcnt(3)
  v_mfma_f32_16x16x32_bf16 v[200:203], v[80:83], v[148:151], v[200:203]
  s_waitcnt lgkmcnt(2)
  v_mfma_f32_16x16x32_bf16 v[204:207], v[84:87], v[148:151], v[204:207]
  s_waitcnt lgkmcnt(1)
  v_mfma_f32_16x16x32_bf16 v[208:211], v[88:91], v[148:151], v[208:211]
  s_waitcnt lgkmcnt(0)
  v_mfma_f32_16x16x32_bf16 v[212:215], v[92:95], v[148:151], v[212:215]
  s_waitcnt vmcnt(4)
  s_mov_b64 exec, 1
  ds_add_u32 v56, v57
  s_mov_b64 exec, -1
  s_add_u32 s78, s78, 4
.Lfs_2:
  ds_read_b32 v58, v56
  s_waitcnt lgkmcnt(0)
  v_readfirstlane_b32 s79, v58
  s_cmp_lt_u32 s79, s78
  s_cbranch_scc1 .Lfs_2
  s_lshl_b32 s73, s75, 7
  s_add_u32 m0, s72, 81920
  s_add_u32 s75, s75, 1
  buffer_load_dwordx4 v40, s[40:43], s73 offen lds
  s_cmp_eq_u32 s75, 9
  s_cselect_b32 s75, 0, s75
  buffer_load_dwordx4 v41, s[40:43], s73 offen offset:1024 lds
  s_lshl_b32 s73, s75, 7
  s_add_u32 m0, s72, 90112
  s_add_u32 s75, s75, 1
  buffer_load_dwordx4 v40, s[40:43], s73 offen lds
  s_cmp_eq_u32 s75, 9
  s_cselect_b32 s75, 0, s75
  buffer_load_dwordx4 v41, s[40:43], s73 offen offset:1024 lds
  ds_read_b128 v[64:67], v60 offset:8192
  ds_read_b128 v[68:71], v60 offset:10240
  ds_read_b128 v[72:75], v60 offset:12288
  ds_read_b128 v[76:79], v60 offset:14336
  ds_read_b128 v[80:83], v61 offset:8192
  ds_read_b128 v[84:87], v61 offset:10240
  ds_read_b128 v[88:91], v61 offset:12288
  ds_read_b128 v[92:95], v61 offset:14336
  s_waitcnt lgkmcnt(7)
  ds_read_b128 v[96:99], v60 offset:16384
  ds_read_b128 v[100:103], v60 offset:18432
  ds_read_b128 v[104:107], v60 offset:20480
  ds_read_b128 v[108:111], v60 offset:22528
  ds_read_b128 v[112:115], v61 offset:16384
  ds_read_b128 v[116:119], v61 offset:18432
  ds_read_b128 v[120:123], v61 offset:20480
  ds_read_b128 v[124:127], v61 offset:22528
  s_waitcnt lgkmcnt(15)
  v_mfma_f32_16x16x32_bf16 v[200:203], v[64:67], v[152:155], v[200:203]
  s_waitcnt lgkmcnt(14)
  v_mfma_f32_16x16x32_bf16 v[204:207], v[68:71], v[152:155], v[204:207]
  s_waitcnt lgkmcnt(13)
  v_mfma_f32_16x16x32_bf16 v[208:211], v[72:75], v[152:155], v[208:211]
  s_waitcnt lgkmcnt(12)
  v_mfma_f32_16x16x32_bf16 v[212:215], v[76:79], v[152:155], v[212:215]
  s_waitcnt lgkmcnt(11)
  v_mfma_f32_16x16x32_bf16 v[200:203], v[80:83], v[156:159], v[200:203]
  s_waitcnt lgkmcnt(10)
  v_mfma_f32_16x16x32_bf16 v[204:207], v[84:87], v[156:159], v[204:207]
  s_waitcnt lgkmcnt(9)
  v_mfma_f32_16x16x32_bf16 v[208:211], v[88:91], v[156:159], v[208:211]
  s_waitcnt lgkmcnt(8)
  v_mfma_f32_16x16x32_bf16 v[212:215], v[92:95], v[156:159], v[212:215]
  s_waitcnt lgkmcnt(7)
  v_mfma_f32_16x16x32_bf16 v[200:203], v[96:99], v[160:163], v[200:203]
  s_waitcnt lgkmcnt(6)
  v_mfma_f32_16x16x32_bf16 v[204:207], v[100:103], v[160:163], v[204:207]
  s_waitcnt lgkmcnt(5)
  v_mfma_f32_16x16x32_bf16 v[208:211], v[104:107], v[160:163], v[208:211]
  s_waitcnt lgkmcnt(4)
  v_mfma_f32_16x16x32_bf16 v[212:215], v[108:111], v[160:163], v[212:215]
  s_waitcnt lgkmcnt(3)
  v_mfma_f32_16x16x32_bf16 v[200:203], v[112:115], v[164:167], v[200:203]
  s_waitcnt lgkmcnt(2)
  v_mfma_f32_16x16x32_bf16 v[204:207], v[116:119], v[164:167], v[204:207]
  s_waitcnt lgkmcnt(1)
  v_mfma_f32_16x16x32_bf16 v[208:211], v[120:123], v[164:167], v[208:211]
  s_waitcnt lgkmcnt(0)
  v_mfma_f32_16x16x32_bf16 v[212:215], v[124:127], v[164:167], v[212:215]
  s_waitcnt vmcnt(4)
  s_mov_b64 exec, 1
  ds_add_u32 v56, v57
  s_mov_b64 exec, -1
  s_add_u32 s78, s78, 4
.Lfs_3:
  ds_read_b32 v58, v56
  s_waitcnt lgkmcnt(0)
  v_readfirstlane_b32 s79, v58
  s_cmp_lt_u32 s79, s78
  s_cbranch_scc1 .Lfs_3
  ds_read_b128 v[64:67], v60 offset:24576
  ds_read_b128 v[68:71], v60 offset:26624
  ds_read_b128 v[72:75], v60 offset:28672
  ds_read_b128 v[76:79], v60 offset:30720
  ds_read_b128 v[80:83], v61 offset:24576
  ds_read_b128 v[84:87], v61 offset:26624
  ds_read_b128 v[88:91], v61 offset:28672
  ds_read_b128 v[92:95], v61 offset:30720
  s_waitcnt lgkmcnt(7)
  ds_read_b128 v[96:99], v60 offset:32768
  ds_read_b128 v[100:103], v60 offset:34816
  ds_read_b128 v[104:107], v60 offset:36864
  ds_read_b128 v[108:111], v60 offset:38912
  ds_read_b128 v[112:115], v61 offset:32768
  ds_read_b128 v[116:119], v61 offset:34816
  ds_read_b128 v[120:123], v61 offset:36864
  ds_read_b128 v[124:127], v61 offset:38912
  s_waitcnt lgkmcnt(15)
  v_mfma_f32_16x16x32_bf16 v[200:203], v[64:67], v[168:171], v[200:203]
  s_waitcnt lgkmcnt(14)
  v_mfma_f32_16x16x32_bf16 v[204:207], v[68:71], v[168:171], v[204:207]
  s_waitcnt lgkmcnt(13)
  v_mfma_f32_16x16x32_bf16 v[208:211], v[72:75], v[168:171], v[208:211]
  s_waitcnt lgkmcnt(12)
  v_mfma_f32_16x16x32_bf16 v[212:215], v[76:79], v[168:171], v[212:215]
  s_waitcnt lgkmcnt(11)
  v_mfma_f32_16x16x32_bf16 v[200:203], v[80:83], v[172:175], v[200:203]
  s_waitcnt lgkmcnt(10)
  v_mfma_f32_16x16x32_bf16 v[204:207], v[84:87], v[172:175], v[204:207]
  s_waitcnt lgkmcnt(9)
  v_mfma_f32_16x16x32_bf16 v[208:211], v[88:91], v[172:175], v[208:211]
  s_waitcnt lgkmcnt(8)
  v_mfma_f32_16x16x32_bf16 v[212:215], v[92:95], v[172:175], v[212:215]
  s_waitcnt lgkmcnt(7)
  v_mfma_f32_16x16x32_bf16 v[200:203], v[96:99], v[176:179], v[200:203]
  s_waitcnt lgkmcnt(6)
  v_mfma_f32_16x16x32_bf16 v[204:207], v[100:103], v[176:179], v[204:207]
  s_waitcnt lgkmcnt(5)
  v_mfma_f32_16x16x32_bf16 v[208:211], v[104:107], v[176:179], v[208:211]
  s_waitcnt lgkmcnt(4)
  v_mfma_f32_16x16x32_bf16 v[212:215], v[108:111], v[176:179], v[212:215]
  s_waitcnt lgkmcnt(3)
  v_mfma_f32_16x16x32_bf16 v[200:203], v[112:115], v[180:183], v[200:203]
  s_waitcnt lgkmcnt(2)
  v_mfma_f32_16x16x32_bf16 v[204:207], v[116:119], v[180:183], v[204:207]
  s_waitcnt lgkmcnt(1)
  v_mfma_f32_16x16x32_bf16 v[208:211], v[120:123], v[180:183], v[208:211]
  s_waitcnt lgkmcnt(0)
  v_mfma_f32_16x16x32_bf16 v[212:215], v[124:127], v[180:183], v[212:215]
  s_waitcnt vmcnt(0)
  s_mov_b64 exec, 1
  ds_add_u32 v56, v57
  s_mov_b64 exec, -1
  s_add_u32 s78, s78, 4
.Lfs_4:
  ds_read_b32 v58, v56
  s_waitcnt lgkmcnt(0)
  v_readfirstlane_b32 s79, v58
  s_cmp_lt_u32 s79, s78
  s_cbranch_scc1 .Lfs_4
  ds_read_b128 v[64:67], v60 offset:40960
  ds_read_b128 v[68:71], v60 offset:43008
  ds_read_b128 v[72:75], v60 offset:45056
  ds_read_b128 v[76:79], v60 offset:47104
  ds_read_b128 v[80:83], v61 offset:40960
  ds_read_b128 v[84:87], v61 offset:43008
  ds_read_b128 v[88:91], v61 offset:45056
  ds_read_b128 v[92:95], v61 offset:47104
  s_waitcnt lgkmcnt(7)
  ds_read_b128 v[96:99], v60 offset:49152
  ds_read_b128 v[100:103], v60 offset:51200
  ds_read_b128 v[104:107], v60 offset:53248
  ds_read_b128 v[108:111], v60 offset:55296
  ds_read_b128 v[112:115], v61 offset:49152
  ds_read_b128 v[116:119], v61 offset:51200
  ds_read_b128 v[120:123], v61 offset:53248
  ds_read_b128 v[124:127], v61 offset:55296
  s_waitcnt lgkmcnt(15)
  v_mfma_f32_16x16x32_bf16 v[200:203], v[64:67], v[184:187], v[200:203]
  s_waitcnt lgkmcnt(14)
  v_mfma_f32_16x16x32_bf16 v[204:207], v[68:71], v[184:187], v[204:207]
  s_waitcnt lgkmcnt(13)
  v_mfma_f32_16x16x32_bf16 v[208:211], v[72:75], v[184:187], v[208:211]
  s_waitcnt lgkmcnt(12)
  v_mfma_f32_16x16x32_bf16 v[212:215], v[76:79], v[184:187], v[212:215]
  s_waitcnt lgkmcnt(11)
  v_mfma_f32_16x16x32_bf16 v[200:203], v[80:83], v[188:191], v[200:203]
  s_waitcnt lgkmcnt(10)
  v_mfma_f32_16x16x32_bf16 v[204:207], v[84:87], v[188:191], v[204:207]
  s_waitcnt lgkmcnt(9)
  v_mfma_f32_16x16x32_bf16 v[208:211], v[88:91], v[188:191], v[208:211]
  s_waitcnt lgkmcnt(8)
  v_mfma_f32_16x16x32_bf16 v[212:215], v[92:95], v[188:191], v[212:215]
  s_waitcnt lgkmcnt(7)
  v_mfma_f32_16x16x32_bf16 v[200:203], v[96:99], v[192:195], v[200:203]
  s_waitcnt lgkmcnt(6)
  v_mfma_f32_16x16x32_bf16 v[204:207], v[100:103], v[192:195], v[204:207]
  s_waitcnt lgkmcnt(5)
  v_mfma_f32_16x16x32_bf16 v[208:211], v[104:107], v[192:195], v[208:211]
  s_waitcnt lgkmcnt(4)
  v_mfma_f32_16x16x32_bf16 v[212:215], v[108:111], v[192:195], v[212:215]
  s_waitcnt lgkmcnt(3)
  v_mfma_f32_16x16x32_bf16 v[200:203], v[112:115], v[196:199], v[200:203]
  s_waitcnt lgkmcnt(2)
  v_mfma_f32_16x16x32_bf16 v[204:207], v[116:119], v[196:199], v[204:207]
  s_waitcnt lgkmcnt(1)
  v_mfma_f32_16x16x32_bf16 v[208:211], v[120:123], v[196:199], v[208:211]
  s_waitcnt lgkmcnt(0)
  v_mfma_f32_16x16x32_bf16 v[212:215], v[124:127], v[196:199], v[212:215]
  s_mul_i32 s73, s94, 9
  s_add_u32 s71, s73, s97
  s_mul_i32 s71, s71, 8448
  s_add_u32 s73, s73, 8
  s_mul_i32 s73, s73, 8448
  s_lshl_b32 s74, s97, 10
  s_mul_i32 s75, s97, 1056
  s_nop 6
  v_cvt_pk_bf16_f32 v80, v200, v201
  v_cvt_pk_bf16_f32 v81, v202, v203
  v_cvt_pk_bf16_f32 v82, v204, v205
  v_cvt_pk_bf16_f32 v83, v206, v207
  v_cvt_pk_bf16_f32 v84, v208, v209
  v_cvt_pk_bf16_f32 v85, v210, v211
  v_cvt_pk_bf16_f32 v86, v212, v213
  v_cvt_pk_bf16_f32 v87, v214, v215
  v_xor_b32 v88, v55, v80
  v_xor_b32 v89, v55, v81
  v_xor_b32 v90, v55, v82
  v_xor_b32 v91, v55, v83
  v_xor_b32 v92, v55, v84
  v_xor_b32 v93, v55, v85
  v_xor_b32 v94, v55, v86
  v_xor_b32 v95, v55, v87
  s_nop 1
  v_mfma_f32_16x16x32_bf16 v[96:99], v[16:19], v[88:91], 0
  v_mfma_f32_16x16x32_bf16 v[112:115], v[24:27], v[80:83], 0
  v_mfma_f32_16x16x32_bf16 v[100:103], v[20:23], v[88:91], 0
  v_mfma_f32_16x16x32_bf16 v[116:119], v[28:31], v[80:83], 0
  v_mfma_f32_16x16x32_bf16 v[104:107], v[16:19], v[92:95], 0
  v_mfma_f32_16x16x32_bf16 v[120:123], v[24:27], v[84:87], 0
  v_mfma_f32_16x16x32_bf16 v[108:111], v[20:23], v[92:95], 0
  v_mfma_f32_16x16x32_bf16 v[124:127], v[28:31], v[84:87], 0
  s_nop 7
  v_subrev_f32_dpp v96, v112, v96 row_ror:8 row_mask:0xf bank_mask:0xf
  v_subrev_f32_dpp v97, v113, v97 row_ror:8 row_mask:0xf bank_mask:0xf
  v_subrev_f32_dpp v98, v114, v98 row_ror:8 row_mask:0xf bank_mask:0xf
  v_subrev_f32_dpp v99, v115, v99 row_ror:8 row_mask:0xf bank_mask:0xf
  v_subrev_f32_dpp v100, v116, v100 row_ror:8 row_mask:0xf bank_mask:0xf
  v_subrev_f32_dpp v101, v117, v101 row_ror:8 row_mask:0xf bank_mask:0xf
  v_subrev_f32_dpp v102, v118, v102 row_ror:8 row_mask:0xf bank_mask:0xf
  v_subrev_f32_dpp v103, v119, v103 row_ror:8 row_mask:0xf bank_mask:0xf
  v_subrev_f32_dpp v104, v120, v104 row_ror:8 row_mask:0xf bank_mask:0xf
  v_subrev_f32_dpp v105, v121, v105 row_ror:8 row_mask:0xf bank_mask:0xf
  v_subrev_f32_dpp v106, v122, v106 row_ror:8 row_mask:0xf bank_mask:0xf
  v_subrev_f32_dpp v107, v123, v107 row_ror:8 row_mask:0xf bank_mask:0xf
  v_subrev_f32_dpp v108, v124, v108 row_ror:8 row_mask:0xf bank_mask:0xf
  v_subrev_f32_dpp v109, v125, v109 row_ror:8 row_mask:0xf bank_mask:0xf
  v_subrev_f32_dpp v110, v126, v110 row_ror:8 row_mask:0xf bank_mask:0xf
  v_subrev_f32_dpp v111, v127, v111 row_ror:8 row_mask:0xf bank_mask:0xf
  v_cvt_pk_bf16_f32 v64, v96, v104
  ds_write_b32 v53, v64 offset:0
  v_cvt_pk_bf16_f32 v65, v97, v105
  ds_write_b32 v53, v65 offset:128
  v_cvt_pk_bf16_f32 v66, v98, v106
  ds_write_b32 v53, v66 offset:256
  v_cvt_pk_bf16_f32 v67, v99, v107
  ds_write_b32 v53, v67 offset:384
  v_cvt_pk_bf16_f32 v68, v100, v108
  ds_write_b32 v53, v68 offset:2048
  v_cvt_pk_bf16_f32 v69, v101, v109
  ds_write_b32 v53, v69 offset:2176
  v_cvt_pk_bf16_f32 v70, v102, v110
  ds_write_b32 v53, v70 offset:2304
  v_cvt_pk_bf16_f32 v71, v103, v111
  ds_write_b32 v53, v71 offset:2432
  s_waitcnt lgkmcnt(0)
  s_mov_b64 exec, 1
  ds_add_u32 v56, v57
  s_mov_b64 exec, -1
  s_add_u32 s78, s78, 4
.Lfs_5:
  ds_read_b32 v58, v56
  s_waitcnt lgkmcnt(0)
  v_readfirstlane_b32 s79, v58
  s_cmp_lt_u32 s79, s78
  s_cbranch_scc1 .Lfs_5
  ds_read_b128 v[218:221], v59 offset:0
  ds_read_b128 v[222:225], v59 offset:1024
  v_mov_b32 v242, v52
  s_waitcnt lgkmcnt(0)
.Ll_s0:
  s_mov_b64 exec, 1
  ds_add_u32 v56, v57
  s_mov_b64 exec, -1
  v_mov_b32 v216, 0
  v_mov_b32 v217, 0
  s_branch .Ljoin
.Lcompute:
  s_waitcnt lgkmcnt(0)
  s_cmp_lg_u32 s93, 0
  s_cbranch_scc1 .Lc_mps
  s_add_u32 s70, s99, 2
  s_sub_u32 s71, s70, 9
  s_cmp_ge_u32 s70, 9
  s_cselect_b32 s70, s71, s70
  s_cmp_lt_u32 s3, 2
  s_cbranch_scc0 .Lc_mpx
  s_cmp_eq_u32 s3, 1
  s_cbranch_scc0 .Lc_mpe
  s_mov_b32 s36, s20
  s_mov_b32 s37, s21
  s_mov_b32 s38, 1990656
  s_mov_b32 s39, 0x20000
  s_lshr_b32 s70, s69, 2
  s_sub_u32 s70, s70, 1
  s_cselect_b32 s70, 8, s70
  s_and_b32 s71, s69, 3
  s_lshl_b32 s71, s71, 4
  v_bfe_u32 v2, v0, 1, 4
  v_add_u32 v2, s71, v2
  v_mul_u32_u24 v2, 3456, v2
  v_and_b32 v3, 1, v0
  v_lshl_add_u32 v2, v3, 7, v2
  s_mul_i32 s70, s70, 221184
  s_lshl_b32 s71, s91, 8
  s_add_u32 s70, s70, s71
  buffer_load_dword v247, v2, s[36:39], s70 offen
  s_branch .Lc_mpe
.Lc_mpx:
  s_cmp_eq_u32 s3, 3
  s_cbranch_scc0 .Lc_mpe
  s_cmp_ge_u32 s69, 24
  s_cbranch_scc0 .Lc_mpe
  s_mov_b32 s32, s18
  s_mov_b32 s33, s19
  s_mov_b32 s34, 2359296
  s_mov_b32 s35, 0x20000
  s_lshl_b32 s71, s90, 7
  v_add_u32 v2, s71, v0
  v_mul_u32_u24 v2, 1152, v2
  s_lshl_b32 s70, s70, 7
  s_add_u32 s71, s70, 73728
  buffer_load_dword v247, v2, s[32:35], s70 offen
  buffer_load_dword v248, v2, s[32:35], s71 offen
  s_branch .Lc_mpe
.Lc_mps:
  s_mov_b32 s40, s8
  s_mov_b32 s41, s9
  s_mov_b32 s42, 2359296
  s_mov_b32 s43, 0x20000
  s_and_b32 s70, s69, 3
  s_lshl_b32 s71, s68, 2
  s_add_u32 s71, s71, s70
  s_lshl_b32 s71, s71, 1
  v_lshrrev_b32 v2, 1, v0
  v_lshlrev_b32 v2, 6, v2
  v_and_b32 v3, 1, v0
  v_add3_u32 v2, v2, v3, s71
  v_mul_u32_u24 v2, 1152, v2
  s_lshl_b32 s72, s3, 7
  buffer_load_dword v244, v2, s[40:43], s72 offen
  buffer_load_dword v245, v2, s[40:43], s72 offen offset:512
  buffer_load_dword v246, v2, s[40:43], 0 offen offset:1024
.Lc_mpe:
  s_mov_b32 s4, s28
  s_mov_b32 s5, s29
  s_mov_b32 s6, 268435456
  s_mov_b32 s7, 0x20000
  s_mov_b32 s60, s22
  s_mov_b32 s61, s23
  s_mov_b32 s62, 663552
  s_mov_b32 s63, 0x20000
  s_mov_b32 s84, s26
  s_mov_b32 s85, s27
  s_mov_b32 s86, 256
  s_mov_b32 s87, 0x20000
  s_mov_b32 s52, s10
  s_mov_b32 s53, s11
  s_mov_b32 s54, 8388608
  s_mov_b32 s55, 0x20000
  s_mov_b32 s56, s12
  s_mov_b32 s57, s13
  s_mov_b32 s58, 8388608
  s_mov_b32 s59, 0x20000
  s_mov_b32 s64, s24
  s_mov_b32 s65, s25
  s_mov_b32 s66, 4718592
  s_mov_b32 s67, 0x20000
  s_lshl_b32 s94, s68, 2
  s_lshr_b32 s95, s69, 3
  s_add_u32 s94, s94, s95
  s_and_b32 s95, s69, 7
  s_lshr_b32 s96, s3, 2
  s_and_b32 s97, s3, 3
  s_mov_b32 s98, 0
  s_cmp_lg_u32 s3, 2
  s_cbranch_scc1 .Lc_nocp
  s_getpc_b64 s[32:33]
.Lc_pc:
  s_sub_u32 s32, s32, .Lc_pc-concat_heads__spectral_fnet__softmax_full_mha__prompt_kernel
  s_subb_u32 s33, s33, 0
  s_mov_b32 s34, .Lcode_end-concat_heads__spectral_fnet__softmax_full_mha__prompt_kernel
  s_mov_b32 s35, 0x20000
  s_mul_i32 s70, s69, 10
  v_min_u32 v2, 9, v0
  v_add_u32 v2, s70, v2
  v_lshlrev_b32 v2, 7, v2
  buffer_load_dword v247, v2, s[32:35], 0 offen
.Lc_nocp:
  s_cmp_lg_u32 s3, 0
  s_cbranch_scc1 .Lc_noinit
  v_mov_b32 v2, 0
  v_mov_b32 v3, 0
  v_lshlrev_b32 v4, 2, v0
  v_add_u32 v5, 162816, v4
  ds_write_b32 v5, v2
  v_lshlrev_b32 v4, 3, v0
  v_add_u32 v4, 162304, v4
  ds_write_b64 v4, v[2:3]
  s_cmp_lg_u32 s2, 0
  s_cbranch_scc1 .Lc_noinit
  s_memrealtime s[88:89]
  s_waitcnt lgkmcnt(0)
  s_or_b32 s89, s89, 0x40000000
  v_mov_b32 v4, s88
  v_mov_b32 v5, s89
  s_mov_b64 exec, 1
  buffer_store_dwordx2 v[4:5], v2, s[84:87], 0 offen sc1
  s_mov_b64 exec, -1
.Lc_noinit:
  s_cmp_lg_u32 s3, 3
  s_cbranch_scc1 .Lc_noones
  v_mov_b32 v8, 0x3f803f80
  v_mov_b32 v9, v8
  v_mov_b32 v10, v8
  v_mov_b32 v11, v8
  v_lshlrev_b32 v5, 4, v0
  v_mov_b32 v12, 0
  v_mov_b32 v13, 0
  v_mov_b32 v14, 0
  v_mov_b32 v15, 0
  v_add_u32 v5, 158976, v5
  ds_write_b128 v5, v[8:11]
  ds_write_b128 v5, v[12:15] offset:1280
.Lc_noones:
  s_cmp_lg_u32 s93, 0
  s_cbranch_scc1 .Lc_spare
  s_and_b32 s70, s3, 1
  s_lshr_b32 s71, s3, 1
  v_and_b32 v2, 31, v0
  v_and_b32 v4, 4, v2
  v_lshlrev_b32 v4, 1, v4
  v_and_b32 v5, 8, v2
  v_lshrrev_b32 v5, 1, v5
  v_and_b32 v3, 0x13, v2
  v_or3_b32 v3, v3, v4, v5
  v_lshrrev_b32 v4, 1, v3
  v_and_b32 v4, 7, v4
  v_lshrrev_b32 v5, 5, v0
  v_xor_b32 v4, v4, v5
  s_lshl_b32 s72, s70, 13
  v_lshlrev_b32 v3, 7, v3
  v_add_u32 v3, s72, v3
  v_xor_b32 v6, 0, v4
  v_lshl_add_u32 v8, v6, 4, v3
  v_xor_b32 v6, 2, v4
  v_lshl_add_u32 v9, v6, 4, v3
  v_xor_b32 v6, 4, v4
  v_lshl_add_u32 v10, v6, 4, v3
  v_xor_b32 v6, 6, v4
  v_lshl_add_u32 v11, v6, 4, v3
  v_and_b32 v3, 15, v0
  v_lshrrev_b32 v4, 2, v3
  v_lshrrev_b32 v5, 5, v0
  v_lshl_add_u32 v5, v5, 3, v4
  v_lshlrev_b32 v5, 8, v5
  v_and_b32 v6, 3, v0
  v_lshlrev_b32 v6, 3, v6
  v_and_b32 v7, 16, v0
  v_lshl_add_u32 v6, v7, 1, v6
  v_add_u32 v5, v5, v6
  v_add_u32 v5, 16384, v5
  s_lshl_b32 s72, s71, 1
  s_add_u32 s73, s72, 0
  v_xor_b32 v6, s73, v4
  v_lshl_add_u32 v12, v6, 6, v5
  s_add_u32 s73, s72, 1
  v_xor_b32 v6, s73, v4
  v_lshl_add_u32 v13, v6, 6, v5
  s_lshl_b32 s72, s91, 7
  s_lshl_b32 s73, s71, 6
  s_add_u32 s75, s72, s73
  v_add_u32 v3, s75, v2
  v_lshrrev_b32 v4, 1, v3
  v_mul_u32_u24 v4, 8448, v4
  v_and_b32 v3, 1, v3
  v_lshl_add_u32 v4, v3, 5, v4
  v_lshrrev_b32 v5, 5, v0
  v_lshl_add_u32 v4, v5, 4, v4
  s_lshl_b32 s72, s90, 9
  s_lshl_b32 s73, s70, 8
  s_add_u32 s72, s72, s73
  v_add_u32 v14, s72, v4
  v_mov_b32 v64, 0
  v_mov_b32 v65, 0
  v_mov_b32 v66, 0
  v_mov_b32 v67, 0
  v_mov_b32 v68, 0
  v_mov_b32 v69, 0
  v_mov_b32 v70, 0
  v_mov_b32 v71, 0
  v_mov_b32 v72, 0
  v_mov_b32 v73, 0
  v_mov_b32 v74, 0
  v_mov_b32 v75, 0
  v_mov_b32 v76, 0
  v_mov_b32 v77, 0
  v_mov_b32 v78, 0
  v_mov_b32 v79, 0
  v_mov_b32 v80, 0
  v_mov_b32 v81, 0
  v_mov_b32 v82, 0
  v_mov_b32 v83, 0
  v_mov_b32 v84, 0
  v_mov_b32 v85, 0
  v_mov_b32 v86, 0
  v_mov_b32 v87, 0
  v_mov_b32 v88, 0
  v_mov_b32 v89, 0
  v_mov_b32 v90, 0
  v_mov_b32 v91, 0
  v_mov_b32 v92, 0
  v_mov_b32 v93, 0
  v_mov_b32 v94, 0
  v_mov_b32 v95, 0
  v_mov_b32 v96, 0
  v_mov_b32 v97, 0
  v_mov_b32 v98, 0
  v_mov_b32 v99, 0
  v_mov_b32 v100, 0
  v_mov_b32 v101, 0
  v_mov_b32 v102, 0
  v_mov_b32 v103, 0
  v_mov_b32 v104, 0
  v_mov_b32 v105, 0
  v_mov_b32 v106, 0
  v_mov_b32 v107, 0
  v_mov_b32 v108, 0
  v_mov_b32 v109, 0
  v_mov_b32 v110, 0
  v_mov_b32 v111, 0
  v_mov_b32 v112, 0
  v_mov_b32 v113, 0
  v_mov_b32 v114, 0
  v_mov_b32 v115, 0
  v_mov_b32 v116, 0
  v_mov_b32 v117, 0
  v_mov_b32 v118, 0
  v_mov_b32 v119, 0
  v_mov_b32 v120, 0
  v_mov_b32 v121, 0
  v_mov_b32 v122, 0
  v_mov_b32 v123, 0
  v_mov_b32 v124, 0
  v_mov_b32 v125, 0
  v_mov_b32 v126, 0
  v_mov_b32 v127, 0
  v_lshrrev_b32 v2, 3, v0
  v_lshlrev_b32 v2, 7, v2
  v_and_b32 v3, 2, v0
  v_lshlrev_b32 v3, 5, v3
  v_and_b32 v4, 4, v0
  v_lshl_add_u32 v3, v4, 3, v3
  v_and_b32 v4, 1, v0
  v_lshl_add_u32 v3, v4, 4, v3
  v_add_u32 v251, v2, v3
  s_and_b32 s79, s3, 1
  s_lshl_b32 s79, s79, 7
  v_xor_b32 v250, s79, v251
  v_and_b32 v3, 4, v0
  v_lshlrev_b32 v3, 4, v3
  v_and_b32 v4, 1, v0
  v_lshl_add_u32 v3, v4, 5, v3
  v_and_b32 v4, 2, v0
  v_lshl_add_u32 v3, v4, 3, v3
  v_add_u32 v252, v2, v3
  s_mov_b32 s72, 0
  s_waitcnt lgkmcnt(0)
  s_barrier
  ds_read_b128 v[16:19], v8
  ds_read_b64_tr_b16 v[24:25], v12 offset:0
  ds_read_b64_tr_b16 v[26:27], v12 offset:1024
  ds_read_b64_tr_b16 v[28:29], v13 offset:0
  ds_read_b64_tr_b16 v[30:31], v13 offset:1024
  ds_read_b128 v[20:23], v8 offset:4096
  ds_read_b128 v[32:35], v9
  ds_read_b64_tr_b16 v[40:41], v12 offset:4096
  ds_read_b64_tr_b16 v[42:43], v12 offset:5120
  ds_read_b64_tr_b16 v[44:45], v13 offset:4096
  ds_read_b64_tr_b16 v[46:47], v13 offset:5120
  ds_read_b128 v[36:39], v9 offset:4096
.Lc_loop:
  s_waitcnt lgkmcnt(6)
  v_mfma_f32_32x32x16_bf16 v[64:79], v[16:19], v[24:27], v[64:79]
  ds_read_b128 v[48:51], v10
  ds_read_b64_tr_b16 v[56:57], v12 offset:8192
  v_mfma_f32_32x32x16_bf16 v[80:95], v[16:19], v[28:31], v[80:95]
  ds_read_b64_tr_b16 v[58:59], v12 offset:9216
  ds_read_b64_tr_b16 v[60:61], v13 offset:8192
  v_mfma_f32_32x32x16_bf16 v[96:111], v[20:23], v[24:27], v[96:111]
  ds_read_b64_tr_b16 v[62:63], v13 offset:9216
  ds_read_b128 v[52:55], v10 offset:4096
  v_mfma_f32_32x32x16_bf16 v[112:127], v[20:23], v[28:31], v[112:127]
  s_waitcnt lgkmcnt(6)
  v_mfma_f32_32x32x16_bf16 v[64:79], v[32:35], v[40:43], v[64:79]
  ds_read_b128 v[128:131], v11
  ds_read_b64_tr_b16 v[136:137], v12 offset:12288
  v_mfma_f32_32x32x16_bf16 v[80:95], v[32:35], v[44:47], v[80:95]
  ds_read_b64_tr_b16 v[138:139], v12 offset:13312
  ds_read_b64_tr_b16 v[140:141], v13 offset:12288
  v_mfma_f32_32x32x16_bf16 v[96:111], v[36:39], v[40:43], v[96:111]
  ds_read_b64_tr_b16 v[142:143], v13 offset:13312
  ds_read_b128 v[132:135], v11 offset:4096
  s_add_u32 s72, s72, 1
  s_and_b32 s74, s72, 3
  s_cselect_b32 s74, 1, -3
  s_lshl_b32 s74, s74, 15
  v_mfma_f32_32x32x16_bf16 v[112:127], v[36:39], v[44:47], v[112:127]
  v_add_u32 v8, s74, v8
  v_add_u32 v9, s74, v9
  v_add_u32 v10, s74, v10
  v_add_u32 v11, s74, v11
  v_add_u32 v12, s74, v12
  v_add_u32 v13, s74, v13
  s_barrier
  s_waitcnt lgkmcnt(6)
  v_mfma_f32_32x32x16_bf16 v[64:79], v[48:51], v[56:59], v[64:79]
  ds_read_b128 v[16:19], v8
  ds_read_b64_tr_b16 v[24:25], v12 offset:0
  v_mfma_f32_32x32x16_bf16 v[80:95], v[48:51], v[60:63], v[80:95]
  ds_read_b64_tr_b16 v[26:27], v12 offset:1024
  ds_read_b64_tr_b16 v[28:29], v13 offset:0
  v_mfma_f32_32x32x16_bf16 v[96:111], v[52:55], v[56:59], v[96:111]
  ds_read_b64_tr_b16 v[30:31], v13 offset:1024
  ds_read_b128 v[20:23], v8 offset:4096
  v_mfma_f32_32x32x16_bf16 v[112:127], v[52:55], v[60:63], v[112:127]
  s_waitcnt lgkmcnt(6)
  v_mfma_f32_32x32x16_bf16 v[64:79], v[128:131], v[136:139], v[64:79]
  ds_read_b128 v[32:35], v9
  ds_read_b64_tr_b16 v[40:41], v12 offset:4096
  v_mfma_f32_32x32x16_bf16 v[80:95], v[128:131], v[140:143], v[80:95]
  ds_read_b64_tr_b16 v[42:43], v12 offset:5120
  ds_read_b64_tr_b16 v[44:45], v13 offset:4096
  v_mfma_f32_32x32x16_bf16 v[96:111], v[132:135], v[136:139], v[96:111]
  ds_read_b64_tr_b16 v[46:47], v13 offset:5120
  ds_read_b128 v[36:39], v9 offset:4096
  v_mfma_f32_32x32x16_bf16 v[112:127], v[132:135], v[140:143], v[112:127]
  s_cmp_lt_u32 s72, 9
  s_cbranch_scc1 .Lc_loop
  s_barrier
  v_mov_b32 v2, 0
  buffer_load_dwordx2 v[4:5], v2, s[84:87], 0 offen sc1
  s_cmp_ge_u32 s75, 1728
  s_cbranch_scc1 .Lc_epi_done
  s_waitcnt lgkmcnt(0)
  s_nop 7
  s_cmp_ge_u32 s75, 576
  s_cbranch_scc1 .Lc_noscale
  s_mov_b32 s76, 1051597459
  s_mov_b32 s77, 1051597459
  v_pk_mul_f32 v[64:65], v[64:65], s[76:77]
  v_pk_mul_f32 v[66:67], v[66:67], s[76:77]
  v_pk_mul_f32 v[68:69], v[68:69], s[76:77]
  v_pk_mul_f32 v[70:71], v[70:71], s[76:77]
  v_pk_mul_f32 v[72:73], v[72:73], s[76:77]
  v_pk_mul_f32 v[74:75], v[74:75], s[76:77]
  v_pk_mul_f32 v[76:77], v[76:77], s[76:77]
  v_pk_mul_f32 v[78:79], v[78:79], s[76:77]
  v_pk_mul_f32 v[80:81], v[80:81], s[76:77]
  v_pk_mul_f32 v[82:83], v[82:83], s[76:77]
  v_pk_mul_f32 v[84:85], v[84:85], s[76:77]
  v_pk_mul_f32 v[86:87], v[86:87], s[76:77]
  v_pk_mul_f32 v[88:89], v[88:89], s[76:77]
  v_pk_mul_f32 v[90:91], v[90:91], s[76:77]
  v_pk_mul_f32 v[92:93], v[92:93], s[76:77]
  v_pk_mul_f32 v[94:95], v[94:95], s[76:77]
  v_pk_mul_f32 v[96:97], v[96:97], s[76:77]
  v_pk_mul_f32 v[98:99], v[98:99], s[76:77]
  v_pk_mul_f32 v[100:101], v[100:101], s[76:77]
  v_pk_mul_f32 v[102:103], v[102:103], s[76:77]
  v_pk_mul_f32 v[104:105], v[104:105], s[76:77]
  v_pk_mul_f32 v[106:107], v[106:107], s[76:77]
  v_pk_mul_f32 v[108:109], v[108:109], s[76:77]
  v_pk_mul_f32 v[110:111], v[110:111], s[76:77]
  v_pk_mul_f32 v[112:113], v[112:113], s[76:77]
  v_pk_mul_f32 v[114:115], v[114:115], s[76:77]
  v_pk_mul_f32 v[116:117], v[116:117], s[76:77]
  v_pk_mul_f32 v[118:119], v[118:119], s[76:77]
  v_pk_mul_f32 v[120:121], v[120:121], s[76:77]
  v_pk_mul_f32 v[122:123], v[122:123], s[76:77]
  v_pk_mul_f32 v[124:125], v[124:125], s[76:77]
  v_pk_mul_f32 v[126:127], v[126:127], s[76:77]
.Lc_noscale:
  s_mov_b32 s76, 135168
  v_cvt_pk_bf16_f32 v16, v64, v65
  v_cvt_pk_bf16_f32 v17, v66, v67
  v_cvt_pk_bf16_f32 v18, v68, v69
  v_cvt_pk_bf16_f32 v19, v70, v71
  buffer_store_dwordx4 v[16:19], v14, s[4:7], 0 offen offset:0 sc1
  v_cvt_pk_bf16_f32 v20, v72, v73
  v_cvt_pk_bf16_f32 v21, v74, v75
  v_cvt_pk_bf16_f32 v22, v76, v77
  v_cvt_pk_bf16_f32 v23, v78, v79
  buffer_store_dwordx4 v[20:23], v14, s[4:7], 0 offen offset:64 sc1
  v_cvt_pk_bf16_f32 v24, v80, v81
  v_cvt_pk_bf16_f32 v25, v82, v83
  v_cvt_pk_bf16_f32 v26, v84, v85
  v_cvt_pk_bf16_f32 v27, v86, v87
  buffer_store_dwordx4 v[24:27], v14, s[4:7], s76 offen offset:0 sc1
  v_cvt_pk_bf16_f32 v28, v88, v89
  v_cvt_pk_bf16_f32 v29, v90, v91
  v_cvt_pk_bf16_f32 v30, v92, v93
  v_cvt_pk_bf16_f32 v31, v94, v95
  buffer_store_dwordx4 v[28:31], v14, s[4:7], s76 offen offset:64 sc1
  v_cvt_pk_bf16_f32 v32, v96, v97
  v_cvt_pk_bf16_f32 v33, v98, v99
  v_cvt_pk_bf16_f32 v34, v100, v101
  v_cvt_pk_bf16_f32 v35, v102, v103
  buffer_store_dwordx4 v[32:35], v14, s[4:7], 0 offen offset:128 sc1
  v_cvt_pk_bf16_f32 v36, v104, v105
  v_cvt_pk_bf16_f32 v37, v106, v107
  v_cvt_pk_bf16_f32 v38, v108, v109
  v_cvt_pk_bf16_f32 v39, v110, v111
  buffer_store_dwordx4 v[36:39], v14, s[4:7], 0 offen offset:192 sc1
  v_cvt_pk_bf16_f32 v40, v112, v113
  v_cvt_pk_bf16_f32 v41, v114, v115
  v_cvt_pk_bf16_f32 v42, v116, v117
  v_cvt_pk_bf16_f32 v43, v118, v119
  buffer_store_dwordx4 v[40:43], v14, s[4:7], s76 offen offset:128 sc1
  v_cvt_pk_bf16_f32 v44, v120, v121
  v_cvt_pk_bf16_f32 v45, v122, v123
  v_cvt_pk_bf16_f32 v46, v124, v125
  v_cvt_pk_bf16_f32 v47, v126, v127
  buffer_store_dwordx4 v[44:47], v14, s[4:7], s76 offen offset:192 sc1
.Lc_epi_done:
  s_waitcnt lgkmcnt(0)
  v_mov_b32 v242, 0
.Lc_pub:
  s_mul_i32 s70, s94, 18
  v_bfe_u32 v6, v0, 4, 1
  v_mul_u32_u24 v6, 17, v6
  v_add_u32 v6, s70, v6
  v_lshrrev_b32 v7, 7, v6
  v_lshrrev_b32 v8, 5, v0
  v_add_u32 v8, 1, v8
  v_mul_u32_u24 v8, 576, v8
  v_add_u32 v6, v6, v8
  v_lshrrev_b32 v6, 7, v6
  v_and_b32 v8, 15, v0
  v_lshl_add_u32 v6, v6, 4, v8
  v_lshlrev_b32 v6, 7, v6
  s_and_b32 s71, s69, 7
  s_lshl_b32 s71, s71, 1
  v_and_b32 v8, 1, v0
  v_add_u32 v8, s71, v8
  v_lshl_add_u32 v7, v7, 4, v8
  v_lshlrev_b32 v7, 7, v7
  s_mov_b32 s83, 0
.Lc_non:
  s_waitcnt vmcnt(0)
  v_readfirstlane_b32 s88, v4
  v_readfirstlane_b32 s89, v5
  s_cmp_lg_u32 s89, 0
  s_cbranch_scc1 .Lc_non_ok
  buffer_load_dwordx2 v[4:5], v2, s[84:87], 0 offen sc1
  s_add_u32 s83, s83, 1
  s_cmp_lt_u32 s83, 65536
  s_cbranch_scc1 .Lc_non
.Lc_non_ok:
  s_cmp_lg_u32 s93, 0
  s_cbranch_scc1 .Lc_noflag
  s_mov_b64 exec, 1
  v_mov_b32 v8, 162820
  v_mov_b32 v9, 1
  ds_add_rtn_u32 v9, v8, v9
  s_lshl_b32 s71, s91, 4
  s_add_u32 s71, s71, s90
  s_lshl_b32 s71, s71, 7
  s_add_u32 s71, s71, 14155776
  s_waitcnt lgkmcnt(0)
  v_readfirstlane_b32 s72, v9
  s_cmp_lg_u32 s72, 3
  s_cbranch_scc1 .Lc_noflag1
  buffer_store_dwordx2 v[4:5], v2, s[4:7], s71 offen sc1
.Lc_noflag1:
  s_mov_b64 exec, -1
.Lc_noflag:
  s_mul_i32 s73, s94, 9
  s_add_u32 s71, s73, s97
  s_mul_i32 s71, s71, 8448
  s_add_u32 s73, s73, 8
  s_mul_i32 s73, s73, 8448
  s_lshl_b32 s74, s97, 10
  s_mul_i32 s75, s97, 1056
  v_add_u32 v216, 14155776, v6
  v_add_u32 v217, 14155776, v7
  s_cmp_lg_u32 s3, 0
  s_cbranch_scc1 .Ljoin
  v_mov_b32 v8, 162824
  ds_write_b64 v8, v[4:5]
  s_cmp_lg_u32 s93, 0
  s_cselect_b64 exec, -1, 1
  buffer_load_dwordx2 v[210:211], v216, s[4:7], 0 offen sc1
  buffer_load_dwordx2 v[212:213], v217, s[4:7], 0 offen sc1
  s_mov_b64 exec, -1
  s_branch .Ljoin
.Ljoin:
  s_lshr_b32 s82, s3, 1
  s_cmp_eq_u32 s96, 0
  s_cselect_b32 s82, s82, s95
  s_cselect_b32 s81, s95, 8
  v_and_b32 v9, 31, v0
  v_lshrrev_b32 v24, 5, v0
  v_and_b32 v10, 4, v9
  v_lshlrev_b32 v10, 1, v10
  v_and_b32 v8, 8, v9
  v_lshrrev_b32 v8, 1, v8
  v_and_b32 v25, 0x13, v9
  v_or3_b32 v25, v25, v10, v8
  v_mul_u32_u24 v8, 5120, v24
  s_and_b32 s79, s3, 1
  s_lshl_b32 s79, s79, 10
  s_add_u32 s79, s79, s94
  v_lshlrev_b32 v26, 5, v9
  v_add_u32 v26, s79, v26
  v_sub_u32 v10, 32, v25
  s_cmp_eq_u32 s82, 0
  s_cselect_b64 vcc, -1, 0
  v_cndmask_b32 v11, v10, v25, vcc
  s_lshl_b32 s79, s81, 5
  v_add_u32 v11, s79, v11
  v_lshl_add_u32 v162, v11, 2, v8
  v_sub_u32 v10, 2048, v26
  v_and_b32 v10, 2047, v10
  v_cndmask_b32 v10, v10, v26, vcc
  v_mul_u32_u24 v10, 2304, v10
  v_lshl_add_u32 v10, v24, 4, v10
  s_sub_u32 s79, 17, s81
  s_cmp_eq_u32 s82, 0
  s_cselect_b32 s79, s81, s79
  s_lshl_b32 s79, s79, 6
  v_add_u32 v161, s79, v10
  v_and_b32 v5, 3, v0
  v_lshlrev_b32 v7, 3, v5
  v_and_b32 v8, 16, v0
  v_lshlrev_b32 v8, 1, v8
  v_and_b32 v9, 4, v0
  v_lshl_add_u32 v8, v9, 4, v8
  v_add_u32 v7, v7, v8
  v_lshrrev_b32 v9, 5, v0
  v_lshlrev_b32 v10, 12, v9
  v_bfe_u32 v11, v0, 3, 1
  v_mul_u32_u24 v12, 1152, v11
  v_add_u32 v10, v10, v12
  v_add_u32 v13, v10, v7
  v_lshlrev_b32 v12, 7, v9
  v_add_u32 v14, v12, v7
  v_add_u32 v14, 8192, v14
  s_lshl_b32 s79, s97, 8
  s_add_u32 s79, s79, 149760
  v_add_u32 v15, s79, v13
  v_xor_b32 v16, 128, v15
  v_add_u32 v17, s79, v14
  s_mul_i32 s79, s96, 37440
  v_add_u32 v6, s79, v14
  v_cmp_eq_u32 vcc, 0, v11
  v_mov_b32 v7, 158976
  v_xor_b32 v203, 1, v11
  v_cndmask_b32 v202, v7, v6, vcc
  v_and_b32 v5, 31, v0
  v_lshrrev_b32 v6, 1, v5
  v_mul_u32_u24 v6, 1056, v6
  v_and_b32 v7, 1, v5
  v_lshl_add_u32 v6, v7, 4, v6
  s_add_u32 s79, s79, 9216
  v_add_u32 v6, s79, v6
  v_lshl_add_u32 v6, v9, 5, v6
  v_cmp_eq_u32 vcc, 18, v5
  v_mov_b32 v7, 158976
  v_mov_b32 v8, 160256
  v_cndmask_b32 v7, v8, v7, vcc
  v_cmp_lt_u32 vcc, 17, v5
  v_xor_b32 v29, 128, v13
  s_nop 0
  v_cndmask_b32 v28, v6, v7, vcc
  v_cndmask_b32_e64 v208, 1, 0, vcc
  v_lshrrev_b32 v5, 4, v0
  v_mul_u32_u24 v5, 1280, v5
  v_and_b32 v209, 15, v0
  v_lshl_add_u32 v209, v209, 3, v5
  v_add_u32 v209, 14303232, v209
  s_lshl_b32 s79, s3, 6
  s_add_u32 s79, s79, 162304
  v_and_b32 v5, 15, v0
  v_lshlrev_b32 v5, 2, v5
  v_add_u32 v253, s79, v5
  s_lshl_b32 s79, s97, 8
  s_add_u32 s79, s79, 161280
  v_lshlrev_b32 v5, 2, v0
  v_add_u32 v19, s79, v5
  s_lshl_b32 s79, s97, 2
  s_add_u32 s79, s79, 162912
  v_mov_b32 v18, s79
.Lat_restart:
  s_mul_i32 s79, s96, 37440
  v_add_u32 v204, s79, v13
  v_add_u32 v205, s79, v29
  v_mov_b32 v206, v202
  v_mov_b32 v207, v28
  v_mov_b32 v128, 0
  v_mov_b32 v129, 0
  v_mov_b32 v130, 0
  v_mov_b32 v131, 0
  v_mov_b32 v132, 0
  v_mov_b32 v133, 0
  v_mov_b32 v134, 0
  v_mov_b32 v135, 0
  v_mov_b32 v136, 0
  v_mov_b32 v137, 0
  v_mov_b32 v138, 0
  v_mov_b32 v139, 0
  v_mov_b32 v140, 0
  v_mov_b32 v141, 0
  v_mov_b32 v142, 0
  v_mov_b32 v143, 0
  v_mov_b32 v144, 0
  v_mov_b32 v145, 0
  v_mov_b32 v146, 0
  v_mov_b32 v147, 0
  v_mov_b32 v148, 0
  v_mov_b32 v149, 0
  v_mov_b32 v150, 0
  v_mov_b32 v151, 0
  v_mov_b32 v152, 0
  v_mov_b32 v153, 0
  v_mov_b32 v154, 0
  v_mov_b32 v155, 0
  v_mov_b32 v156, 0
  v_mov_b32 v157, 0
  v_mov_b32 v158, 0
  v_mov_b32 v159, 0
  v_mov_b32 v88, 0
  v_mov_b32 v92, 0
  v_mov_b32 v188, 0
  v_mov_b32 v89, 0
  v_mov_b32 v93, 0
  v_mov_b32 v189, 0
  v_mov_b32 v90, 0
  v_mov_b32 v94, 0
  v_mov_b32 v190, 0
  v_mov_b32 v91, 0
  v_mov_b32 v95, 0
  v_mov_b32 v191, 0
  v_mov_b32 v160, 0xdddddddd
  s_lshr_b32 s79, s97, 1
  s_lshr_b32 s80, s95, 1
  s_or_b32 s79, s79, s80
  s_cmp_eq_u32 s79, 0
  s_cselect_b32 s1, s96, 0
  s_cmp_eq_u32 s3, 4
  s_cselect_b32 s79, 5, 1
  s_lshl_b32 s80, s1, 2
  s_or_b32 s80, s80, s79
  s_cmp_eq_u32 s96, 0
  s_cselect_b32 s31, 15, s80
  s_cselect_b32 s30, 13, s79
  s_mov_b32 s70, 18720
  s_cselect_b32 s72, 0x23, 0x22
  s_cmp_eq_u32 s3, 4
  s_cselect_b32 s0, 7, 6
  s_cmp_lt_u32 s95, 2
  s_cselect_b32 s0, 7, s0
  s_cmp_eq_u32 s1, 0
  s_cselect_b32 s0, s0, 8
  s_cmp_eq_u32 s96, 0
  s_cselect_b32 s0, 64, s0
  s_cmp_lg_u32 s98, 0
  s_cbranch_scc1 .Lat_truemax
  s_cmp_lg_u32 s3, 0
  s_cbranch_scc1 .Lat_wgo
  s_waitcnt vmcnt(0)
  s_cmp_eq_u32 s93, 0
  s_cselect_b32 s79, 4, 0
  v_mov_b32 v8, 162820
  v_mov_b32 v10, s79
  s_mov_b32 s79, 0
  s_cmp_eq_u32 s93, 0
  s_cbranch_scc1 .Lat_p0
  v_cmp_ne_u64 s[80:81], s[88:89], v[210:211]
  v_cmp_ne_u64 s[82:83], s[88:89], v[212:213]
  s_nop 1
  s_or_b64 vcc, s[80:81], s[82:83]
  s_cbranch_scc0 .Lat_f1s
  s_branch .Lat_p1x
.Lat_p0:
  s_mov_b64 s[80:81], -1
  s_mov_b64 s[82:83], -1
  s_mov_b64 exec, 1
.Lat_p1:
  v_cmp_ne_u64 vcc, s[88:89], v[212:213]
  s_add_u32 s79, s79, 1
  s_cbranch_vccz .Lat_p1x
  s_cmp_ge_u32 s79, 3
  s_cbranch_scc1 .Lat_p1x
  buffer_load_dwordx2 v[212:213], v217, s[4:7], 0 offen sc1
  s_waitcnt vmcnt(0)
  s_branch .Lat_p1
.Lat_p1x:
  s_or_b64 exec, s[80:81], 1
  buffer_load_dwordx2 v[32:33], v216, s[4:7], 0 offen sc1
  s_or_b64 exec, s[82:83], 1
  buffer_load_dwordx2 v[34:35], v217, s[4:7], 0 offen sc1
  s_mov_b64 exec, -1
.Lat_pp:
  s_or_b64 exec, s[80:81], 1
  buffer_load_dwordx2 v[36:37], v216, s[4:7], 0 offen sc1
  s_or_b64 exec, s[82:83], 1
  buffer_load_dwordx2 v[38:39], v217, s[4:7], 0 offen sc1
  s_mov_b64 exec, -1
  ds_read_b32 v9, v8
  s_waitcnt vmcnt(2) lgkmcnt(0)
  v_cmp_ne_u64 vcc, s[88:89], v[32:33]
  s_and_b64 s[80:81], s[80:81], vcc
  v_cmp_ne_u64 vcc, s[88:89], v[34:35]
  s_and_b64 s[82:83], s[82:83], vcc
  s_or_b64 vcc, s[80:81], s[82:83]
  s_cbranch_scc0 .Lat_f1t
  s_or_b64 exec, s[80:81], 1
  buffer_load_dwordx2 v[32:33], v216, s[4:7], 0 offen sc1
  s_or_b64 exec, s[82:83], 1
  buffer_load_dwordx2 v[34:35], v217, s[4:7], 0 offen sc1
  s_mov_b64 exec, -1
  ds_read_b32 v9, v8
  s_waitcnt vmcnt(2) lgkmcnt(0)
  v_cmp_ne_u64 vcc, s[88:89], v[36:37]
  s_and_b64 s[80:81], s[80:81], vcc
  v_cmp_ne_u64 vcc, s[88:89], v[38:39]
  s_and_b64 s[82:83], s[82:83], vcc
  s_or_b64 vcc, s[80:81], s[82:83]
  s_cbranch_scc0 .Lat_f1t
  s_add_u32 s79, s79, 1
  s_cmp_lt_u32 s79, 65536
  s_cbranch_scc1 .Lat_pp
.Lat_f1s:
  ds_read_b32 v9, v8
  s_waitcnt lgkmcnt(0)
.Lat_f1t:
  v_cmp_lt_u32 vcc, v9, v10
  s_cbranch_vccnz .Lat_f1s
  v_mov_b32 v8, 162832
  v_mov_b32 v9, 1
  ds_write_b32 v8, v9
  s_branch .Lat_go0
.Lat_wgo:
  v_mov_b32 v8, 162832
.Lsp_6:
  ds_read_b32 v9, v8
  s_waitcnt lgkmcnt(0)
  v_readfirstlane_b32 s79, v9
  s_cmp_lt_u32 s79, 1
  s_cbranch_scc1 .Lsp_6
  s_cmp_lg_u32 s96, 0
  s_cbranch_scc1 .Lat_w47
.Lat_go0:
  s_add_u32 m0, s74, 149760
  s_mov_b32 s77, s71
  s_lshl_b32 s79, s95, 10
  s_add_u32 s77, s77, s79
  buffer_load_dwordx4 v250, s[4:7], s77 offen sc1 lds
  s_add_u32 m0, s74, 153856
  s_add_u32 s77, s71, 33792
  s_lshl_b32 s79, s95, 10
  s_add_u32 s77, s77, s79
  buffer_load_dwordx4 v250, s[4:7], s77 offen sc1 lds
  s_add_u32 m0, s74, 0
  s_add_u32 s77, s71, 2433024
  buffer_load_dwordx4 v250, s[4:7], s77 offen sc1 lds
  s_add_u32 m0, s74, 4096
  s_add_u32 s77, s71, 2466816
  buffer_load_dwordx4 v250, s[4:7], s77 offen sc1 lds
  s_add_u32 m0, s75, 9216
  s_add_u32 s77, s71, 4866048
  buffer_load_dwordx4 v252, s[4:7], s77 offen sc1 lds
  s_add_u32 m0, s75, 13440
  s_add_u32 s77, s71, 4899840
  buffer_load_dwordx4 v252, s[4:7], s77 offen sc1 lds
  s_cmp_lg_u32 s97, 0
  s_cbranch_scc1 .Lr8_8
  s_mov_b32 m0, 157952
  s_lshl_b32 s77, s95, 10
  s_add_u32 s77, s77, s73
  buffer_load_dwordx4 v251, s[4:7], s77 offen sc1 lds
  s_branch .Lr8_7
.Lr8_8:
  s_cmp_lg_u32 s97, 1
  s_cbranch_scc1 .Lr8_9
  s_mov_b32 m0, 8192
  s_add_u32 s77, s73, 2433024
  buffer_load_dwordx4 v251, s[4:7], s77 offen sc1 lds
  s_branch .Lr8_7
.Lr8_9:
  s_cmp_lg_u32 s97, 2
  s_cbranch_scc1 .Lr8_10
  s_mov_b32 m0, 17664
  s_add_u32 s77, s73, 4866048
  buffer_load_dwordx4 v252, s[4:7], s77 offen sc1 lds
  s_branch .Lr8_7
.Lr8_10:
  s_mov_b32 m0, 17664
  s_add_u32 s77, s73, 4866048
  buffer_load_dwordx4 v252, s[4:7], s77 offen sc1 lds
.Lr8_7:
  s_add_u32 m0, s74, 18720
  s_add_u32 s77, s71, 2434048
  buffer_load_dwordx4 v250, s[4:7], s77 offen sc1 lds
  s_add_u32 m0, s74, 22816
  s_add_u32 s77, s71, 2467840
  buffer_load_dwordx4 v250, s[4:7], s77 offen sc1 lds
  s_add_u32 m0, s75, 27936
  s_add_u32 s77, s71, 4867072
  buffer_load_dwordx4 v252, s[4:7], s77 offen sc1 lds
  s_add_u32 m0, s75, 32160
  s_add_u32 s77, s71, 4900864
  buffer_load_dwordx4 v252, s[4:7], s77 offen sc1 lds
  s_cmp_lg_u32 s97, 0
  s_cbranch_scc1 .Lr8_13
  s_mov_b32 m0, 26912
  s_add_u32 s77, s73, 2434048
  buffer_load_dwordx4 v251, s[4:7], s77 offen sc1 lds
  s_branch .Lr8_12
.Lr8_13:
  s_cmp_lg_u32 s97, 1
  s_cbranch_scc1 .Lr8_14
  s_mov_b32 m0, 36384
  s_add_u32 s77, s73, 4867072
  buffer_load_dwordx4 v252, s[4:7], s77 offen sc1 lds
  s_branch .Lr8_12
.Lr8_14:
  s_cmp_lg_u32 s97, 2
  s_cbranch_scc1 .Lr8_15
  s_mov_b32 m0, 26912
  s_add_u32 s77, s73, 2434048
  buffer_load_dwordx4 v251, s[4:7], s77 offen sc1 lds
  s_branch .Lr8_12
.Lr8_15:
  s_mov_b32 m0, 36384
  s_add_u32 s77, s73, 4867072
  buffer_load_dwordx4 v252, s[4:7], s77 offen sc1 lds
.Lr8_12:
  s_setprio 1
  s_waitcnt vmcnt(5)
  v_mov_b32 v8, 162848
  v_mov_b32 v9, 1
  s_mov_b64 exec, 1
  ds_add_u32 v8, v9
  s_mov_b64 exec, -1
  s_cmp_eq_u32 s93, 0
  s_cbranch_scc1 .Lat_nog0
  s_mov_b32 s79, 327680
  buffer_store_dwordx4 v[218:221], v242, s[4:7], 0 offen offset:0 sc1
  buffer_store_dwordx4 v[222:225], v242, s[4:7], s79 offen offset:0 sc1
.Lat_nog0:
  v_mov_b32 v8, 162848
.Lsp_17:
  ds_read_b32 v9, v8
  s_waitcnt lgkmcnt(0)
  v_readfirstlane_b32 s79, v9
  s_cmp_lt_u32 s79, 4
  s_cbranch_scc1 .Lsp_17
  ds_read_b64_tr_b16 v[192:193], v15
  ds_read_b64_tr_b16 v[194:195], v15 offset:2048
  ds_read_b64_tr_b16 v[196:197], v16
  ds_read_b64_tr_b16 v[198:199], v16 offset:2048
  ds_read_b64_tr_b16 v[200:201], v17
  ds_read_b64_tr_b16 v[176:177], v204
  ds_read_b64_tr_b16 v[178:179], v204 offset:2048
  ds_read_b64_tr_b16 v[180:181], v206
  s_waitcnt lgkmcnt(0)
  v_mov_b32 v201, 0
  v_mov_b32 v22, 0
  s_nop 0
  v_mfma_f32_32x32x16_bf16 v[32:47], v[176:179], v[192:195], 0
  v_mfma_f32_32x32x16_bf16 v[48:63], v[176:179], v[196:199], 0
  ds_read_b64_tr_b16 v[176:177], v205
  ds_read_b64_tr_b16 v[178:179], v205 offset:2048
  ds_read_b128 v[184:187], v207
  s_nop 6
  v_mfma_f32_32x32x4_2b_bf16 v[32:63], v[180:181], v[200:201], v[32:63] cbsz:1 abid:0
  s_nop 7
  s_nop 7
  s_nop 3
  v_max3_f32 v20, v32, v33, v34
  v_max3_f32 v20, v20, v35, v36
  v_max3_f32 v20, v20, v37, v38
  v_max3_f32 v20, v20, v39, v40
  v_max3_f32 v20, v20, v41, v42
  v_max3_f32 v20, v20, v43, v44
  v_max3_f32 v20, v20, v45, v46
  v_max_f32 v20, v20, v47
  v_max3_f32 v21, v48, v49, v50
  v_max3_f32 v21, v21, v51, v52
  v_max3_f32 v21, v21, v53, v54
  v_max3_f32 v21, v21, v55, v56
  v_max3_f32 v21, v21, v57, v58
  v_max3_f32 v21, v21, v59, v60
  v_max3_f32 v21, v21, v61, v62
  v_max_f32 v21, v21, v63
  s_nop 1
  v_permlane32_swap_b32 v20, v21
  s_nop 1
  v_max_f32 v20, v20, v21
  v_sub_f32 v20, 3267887104, v20
  v_and_b32 v21, 0xffff0000, v20
  v_sub_f32 v20, v20, v21
  v_cvt_pk_bf16_f32 v201, v21, v20
  v_mov_b32 v23, v201
  ds_write_b32 v19, v201
  v_mov_b32 v9, 1
  v_mfma_f32_32x32x4_2b_bf16 v[32:63], v[180:181], v[22:23], v[32:63] cbsz:1 abid:0
  s_waitcnt lgkmcnt(0)
  ds_write_b32 v18, v9
  s_branch .Lat_run
.Lat_w47:
  s_cmp_eq_u32 s93, 0
  s_cselect_b32 s80, 24, 24
  v_mov_b32 v8, 162816
.Lsp_18:
  ds_read_b32 v9, v8
  s_waitcnt lgkmcnt(0)
  v_readfirstlane_b32 s79, v9
  s_cmp_lt_u32 s79, s80
  s_cbranch_scc1 .Lsp_18
  s_add_u32 m0, s74, 37440
  s_add_u32 s77, s71, 2437120
  buffer_load_dwordx4 v250, s[4:7], s77 offen sc1 lds
  s_add_u32 m0, s74, 41536
  s_add_u32 s77, s71, 2470912
  buffer_load_dwordx4 v250, s[4:7], s77 offen sc1 lds
  s_add_u32 m0, s75, 46656
  s_add_u32 s77, s71, 4870144
  buffer_load_dwordx4 v252, s[4:7], s77 offen sc1 lds
  s_add_u32 m0, s75, 50880
  s_add_u32 s77, s71, 4903936
  buffer_load_dwordx4 v252, s[4:7], s77 offen sc1 lds
  s_cmp_lg_u32 s97, 0
  s_cbranch_scc1 .Lr8_20
  s_mov_b32 m0, 45632
  s_add_u32 s77, s73, 2437120
  buffer_load_dwordx4 v251, s[4:7], s77 offen sc1 lds
  s_branch .Lr8_19
.Lr8_20:
  s_cmp_lg_u32 s97, 1
  s_cbranch_scc1 .Lr8_21
  s_mov_b32 m0, 55104
  s_add_u32 s77, s73, 4870144
  buffer_load_dwordx4 v252, s[4:7], s77 offen sc1 lds
  s_branch .Lr8_19
.Lr8_21:
  s_cmp_lg_u32 s97, 2
  s_cbranch_scc1 .Lr8_22
  s_mov_b32 m0, 64352
  s_add_u32 s77, s73, 2438144
  buffer_load_dwordx4 v251, s[4:7], s77 offen sc1 lds
  s_branch .Lr8_19
.Lr8_22:
  s_mov_b32 m0, 73824
  s_add_u32 s77, s73, 4871168
  buffer_load_dwordx4 v252, s[4:7], s77 offen sc1 lds
.Lr8_19:
  s_waitcnt vmcnt(0)
  v_mov_b32 v8, 162852
  v_mov_b32 v9, 1
  s_mov_b64 exec, 1
  ds_add_u32 v8, v9
  s_mov_b64 exec, -1
  s_add_u32 m0, s74, 56160
  s_add_u32 s77, s71, 2438144
  buffer_load_dwordx4 v250, s[4:7], s77 offen sc1 lds
  s_add_u32 m0, s74, 60256
  s_add_u32 s77, s71, 2471936
  buffer_load_dwordx4 v250, s[4:7], s77 offen sc1 lds
  s_add_u32 m0, s75, 65376
  s_add_u32 s77, s71, 4871168
  buffer_load_dwordx4 v252, s[4:7], s77 offen sc1 lds
  s_add_u32 m0, s75, 69600
  s_add_u32 s77, s71, 4904960
  buffer_load_dwordx4 v252, s[4:7], s77 offen sc1 lds
  s_add_u32 m0, s74, 74880
  s_add_u32 s77, s71, 2435072
  buffer_load_dwordx4 v250, s[4:7], s77 offen sc1 lds
  s_add_u32 m0, s74, 78976
  s_add_u32 s77, s71, 2468864
  buffer_load_dwordx4 v250, s[4:7], s77 offen sc1 lds
  s_add_u32 m0, s75, 84096
  s_add_u32 s77, s71, 4868096
  buffer_load_dwordx4 v252, s[4:7], s77 offen sc1 lds
  s_add_u32 m0, s75, 88320
  s_add_u32 s77, s71, 4901888
  buffer_load_dwordx4 v252, s[4:7], s77 offen sc1 lds
  s_add_u32 m0, s74, 93600
  s_add_u32 s77, s71, 2439168
  buffer_load_dwordx4 v250, s[4:7], s77 offen sc1 lds
  s_add_u32 m0, s74, 97696
  s_add_u32 s77, s71, 2472960
  buffer_load_dwordx4 v250, s[4:7], s77 offen sc1 lds
  s_add_u32 m0, s75, 102816
  s_add_u32 s77, s71, 4872192
  buffer_load_dwordx4 v252, s[4:7], s77 offen sc1 lds
  s_add_u32 m0, s75, 107040
  s_add_u32 s77, s71, 4905984
  buffer_load_dwordx4 v252, s[4:7], s77 offen sc1 lds
  s_cmp_lg_u32 s97, 0
  s_cbranch_scc1 .Lr8_25
  s_mov_b32 m0, 83072
  s_add_u32 s77, s73, 2435072
  buffer_load_dwordx4 v251, s[4:7], s77 offen sc1 lds
  s_branch .Lr8_24
.Lr8_25:
  s_cmp_lg_u32 s97, 1
  s_cbranch_scc1 .Lr8_26
  s_mov_b32 m0, 92544
  s_add_u32 s77, s73, 4868096
  buffer_load_dwordx4 v252, s[4:7], s77 offen sc1 lds
  s_branch .Lr8_24
.Lr8_26:
  s_cmp_lg_u32 s97, 2
  s_cbranch_scc1 .Lr8_27
  s_mov_b32 m0, 101792
  s_add_u32 s77, s73, 2439168
  buffer_load_dwordx4 v251, s[4:7], s77 offen sc1 lds
  s_branch .Lr8_24
.Lr8_27:
  s_mov_b32 m0, 111264
  s_add_u32 s77, s73, 4872192
  buffer_load_dwordx4 v252, s[4:7], s77 offen sc1 lds
.Lr8_24:
  s_add_u32 m0, s74, 112320
  s_add_u32 s77, s71, 2436096
  buffer_load_dwordx4 v250, s[4:7], s77 offen sc1 lds
  s_add_u32 m0, s74, 116416
  s_add_u32 s77, s71, 2469888
  buffer_load_dwordx4 v250, s[4:7], s77 offen sc1 lds
  s_add_u32 m0, s75, 121536
  s_add_u32 s77, s71, 4869120
  buffer_load_dwordx4 v252, s[4:7], s77 offen sc1 lds
  s_add_u32 m0, s75, 125760
  s_add_u32 s77, s71, 4902912
  buffer_load_dwordx4 v252, s[4:7], s77 offen sc1 lds
  s_add_u32 m0, s74, 131040
  s_add_u32 s77, s71, 2440192
  buffer_load_dwordx4 v250, s[4:7], s77 offen sc1 lds
  s_add_u32 m0, s74, 135136
  s_add_u32 s77, s71, 2473984
  buffer_load_dwordx4 v250, s[4:7], s77 offen sc1 lds
  s_add_u32 m0, s75, 140256
  s_add_u32 s77, s71, 4873216
  buffer_load_dwordx4 v252, s[4:7], s77 offen sc1 lds
  s_add_u32 m0, s75, 144480
  s_add_u32 s77, s71, 4907008
  buffer_load_dwordx4 v252, s[4:7], s77 offen sc1 lds
  s_cmp_lg_u32 s97, 0
  s_cbranch_scc1 .Lr8_30
  s_mov_b32 m0, 120512
  s_add_u32 s77, s73, 2436096
  buffer_load_dwordx4 v251, s[4:7], s77 offen sc1 lds
  s_branch .Lr8_29
.Lr8_30:
  s_cmp_lg_u32 s97, 1
  s_cbranch_scc1 .Lr8_31
  s_mov_b32 m0, 129984
  s_add_u32 s77, s73, 4869120
  buffer_load_dwordx4 v252, s[4:7], s77 offen sc1 lds
  s_branch .Lr8_29
.Lr8_31:
  s_cmp_lg_u32 s97, 2
  s_cbranch_scc1 .Lr8_32
  s_mov_b32 m0, 139232
  s_add_u32 s77, s73, 2440192
  buffer_load_dwordx4 v251, s[4:7], s77 offen sc1 lds
  s_branch .Lr8_29
.Lr8_32:
  s_mov_b32 m0, 148704
  s_add_u32 s77, s73, 4873216
  buffer_load_dwordx4 v252, s[4:7], s77 offen sc1 lds
.Lr8_29:
  s_mov_b32 s79, 327680
  buffer_store_dwordx4 v[218:221], v242, s[4:7], 0 offen offset:0 sc1
  buffer_store_dwordx4 v[222:225], v242, s[4:7], s79 offen offset:0 sc1
  s_cmp_eq_u32 s93, 0
  s_cbranch_scc1 .Lat_nog
  s_mov_b32 s79, 327680
  buffer_store_dwordx4 v[226:229], v242, s[4:7], 0 offen offset:128 sc1
  buffer_store_dwordx4 v[230:233], v242, s[4:7], s79 offen offset:128 sc1
.Lat_nog:
  s_lshl_b32 s79, s94, 16
  s_lshl_b32 s80, s95, 12
  s_add_u32 s79, s79, s80
  s_lshl_b32 s80, s97, 10
  s_add_u32 s79, s79, s80
  s_add_u32 s79, s79, 9961472
  v_lshlrev_b32 v164, 4, v0
  v_add_u32 v164, s79, v164
  s_lshl_b32 s79, s94, 13
  s_lshl_b32 s80, s95, 10
  s_add_u32 s79, s79, s80
  s_lshl_b32 s80, s97, 8
  s_add_u32 s79, s79, s80
  s_add_u32 s79, s79, 12058624
  v_lshlrev_b32 v165, 2, v0
  v_add_u32 v165, s79, v165
  v_mov_b32 v168, -1
  v_mov_b32 v169, -1
  v_mov_b32 v170, -1
  v_mov_b32 v171, -1
  s_mov_b32 s79, 32768
  buffer_store_dwordx4 v[168:171], v164, s[4:7], 0 offen sc1
  buffer_store_dwordx4 v[168:171], v164, s[4:7], s79 offen sc1
  buffer_store_dword v168, v165, s[4:7], 0 offen sc1
  v_mov_b32 v8, 162848
.Lsp_34:
  ds_read_b64 v[10:11], v8
  s_waitcnt lgkmcnt(0)
  v_min_u32 v9, v10, v11
  s_nop 0
  v_readfirstlane_b32 s79, v9
  s_cmp_lt_u32 s79, 4
  s_cbranch_scc1 .Lsp_34
  ds_read_b64_tr_b16 v[192:193], v15
  ds_read_b64_tr_b16 v[194:195], v15 offset:2048
  ds_read_b64_tr_b16 v[196:197], v16
  ds_read_b64_tr_b16 v[198:199], v16 offset:2048
  ds_read_b64_tr_b16 v[200:201], v17
  ds_read_b64_tr_b16 v[176:177], v204
  ds_read_b64_tr_b16 v[178:179], v204 offset:2048
  ds_read_b64_tr_b16 v[180:181], v206
  v_mov_b32 v5, 162824
  ds_read_b64 v[6:7], v5
.Lmx_35:
  ds_read_b32 v9, v18
  s_waitcnt lgkmcnt(0)
  v_readfirstlane_b32 s79, v9
  s_cmp_eq_u32 s79, 0
  s_cbranch_scc1 .Lmx_35
  s_setprio 2
  ds_read_b32 v201, v19
  v_readfirstlane_b32 s88, v6
  v_readfirstlane_b32 s89, v7
.Lat_qk:
  s_waitcnt lgkmcnt(0)
  v_mfma_f32_32x32x16_bf16 v[32:47], v[176:179], v[192:195], 0
  v_mfma_f32_32x32x16_bf16 v[48:63], v[176:179], v[196:199], 0
  ds_read_b64_tr_b16 v[176:177], v205
  ds_read_b64_tr_b16 v[178:179], v205 offset:2048
  ds_read_b128 v[184:187], v207
  s_nop 6
  v_mfma_f32_32x32x4_2b_bf16 v[32:63], v[180:181], v[200:201], v[32:63] cbsz:1 abid:0
.Lat_run:
  s_mov_b32 s99, 0
  s_waitcnt lgkmcnt(0)
  s_nop 7
  s_nop 7
  s_nop 0
.Lat_loop:
  v_mfma_f32_32x32x16_bf16 v[64:79], v[176:179], v[192:195], 0
  v_exp_f32 v32, v32
  v_exp_f32 v33, v33
  v_exp_f32 v34, v34
  v_exp_f32 v35, v35
  v_smfmac_f32_32x32x32_bf16 v[144:159], v[188:191], v[88:95], v160
  s_waitcnt lgkmcnt(0)
  ds_read_b128 v[188:191], v207 offset:64
  v_exp_f32 v36, v36
  v_exp_f32 v37, v37
  v_exp_f32 v38, v38
  v_exp_f32 v39, v39
  v_mfma_f32_32x32x16_bf16 v[80:95], v[176:179], v[196:199], 0
  ds_read_b64_tr_b16 v[176:177], v204 offset:256
  ds_read_b64_tr_b16 v[178:179], v204 offset:2304
  v_exp_f32 v40, v40
  v_exp_f32 v41, v41
  v_exp_f32 v42, v42
  v_exp_f32 v43, v43
  v_smfmac_f32_32x32x32_bf16 v[128:143], v[184:187], v[32:39], v160
  s_waitcnt lgkmcnt(2)
  v_exp_f32 v44, v44
  v_exp_f32 v45, v45
  v_exp_f32 v46, v46
  v_exp_f32 v47, v47
  v_mfma_f32_32x32x4_2b_bf16 v[64:95], v[180:181], v[200:201], v[64:95] cbsz:1 abid:1
  ds_read_b64_tr_b16 v[180:181], v206 offset:256
  v_exp_f32 v48, v48
  v_exp_f32 v49, v49
  v_exp_f32 v50, v50
  v_exp_f32 v51, v51
  v_exp_f32 v52, v52
  v_exp_f32 v53, v53
  v_smfmac_f32_32x32x32_bf16 v[128:143], v[188:191], v[40:47], v160
  v_exp_f32 v54, v54
  v_exp_f32 v55, v55
  v_exp_f32 v56, v56
  v_exp_f32 v57, v57
  v_exp_f32 v58, v58
  v_smfmac_f32_32x32x32_bf16 v[144:159], v[184:187], v[48:55], v160
  s_waitcnt lgkmcnt(0)
  ds_read_b128 v[184:187], v207 offset:128
  v_exp_f32 v59, v59
  v_exp_f32 v60, v60
  v_exp_f32 v61, v61
  v_exp_f32 v62, v62
  v_exp_f32 v63, v63
  v_mfma_f32_32x32x16_bf16 v[32:47], v[176:179], v[192:195], 0
  v_exp_f32 v64, v64
  v_exp_f32 v65, v65
  v_exp_f32 v66, v66
  v_exp_f32 v67, v67
  v_smfmac_f32_32x32x32_bf16 v[144:159], v[188:191], v[56:63], v160
  s_waitcnt lgkmcnt(0)
  ds_read_b128 v[188:191], v207 offset:192
  v_exp_f32 v68, v68
  v_exp_f32 v69, v69
  v_exp_f32 v70, v70
  v_exp_f32 v71, v71
  v_mfma_f32_32x32x16_bf16 v[48:63], v[176:179], v[196:199], 0
  ds_read_b64_tr_b16 v[176:177], v205 offset:256
  ds_read_b64_tr_b16 v[178:179], v205 offset:2304
  v_exp_f32 v72, v72
  v_exp_f32 v73, v73
  v_exp_f32 v74, v74
  v_exp_f32 v75, v75
  v_smfmac_f32_32x32x32_bf16 v[128:143], v[184:187], v[64:71], v160
  s_waitcnt lgkmcnt(2)
  v_exp_f32 v76, v76
  v_exp_f32 v77, v77
  v_exp_f32 v78, v78
  v_exp_f32 v79, v79
  v_mfma_f32_32x32x4_2b_bf16 v[32:63], v[180:181], v[200:201], v[32:63] cbsz:1 abid:0
  v_exp_f32 v80, v80
  v_exp_f32 v81, v81
  v_exp_f32 v82, v82
  v_exp_f32 v83, v83
  v_exp_f32 v84, v84
  v_exp_f32 v85, v85
  v_smfmac_f32_32x32x32_bf16 v[128:143], v[188:191], v[72:79], v160
  v_exp_f32 v86, v86
  v_exp_f32 v87, v87
  v_exp_f32 v88, v88
  v_exp_f32 v89, v89
  v_exp_f32 v90, v90
  v_smfmac_f32_32x32x32_bf16 v[144:159], v[184:187], v[80:87], v160
  s_waitcnt lgkmcnt(0)
  ds_read_b128 v[184:187], v207 offset:256
  v_exp_f32 v91, v91
  v_exp_f32 v92, v92
  v_exp_f32 v93, v93
  v_exp_f32 v94, v94
  v_exp_f32 v95, v95
  v_mfma_f32_32x32x16_bf16 v[64:79], v[176:179], v[192:195], 0
  ds_write_b32 v253, v204
  v_exp_f32 v32, v32
  v_exp_f32 v33, v33
  v_exp_f32 v34, v34
  v_exp_f32 v35, v35
  v_smfmac_f32_32x32x32_bf16 v[144:159], v[188:191], v[88:95], v160
  s_waitcnt lgkmcnt(0)
  ds_read_b128 v[188:191], v207 offset:320
  v_exp_f32 v36, v36
  v_exp_f32 v37, v37
  v_exp_f32 v38, v38
  v_exp_f32 v39, v39
  v_mfma_f32_32x32x16_bf16 v[80:95], v[176:179], v[196:199], 0
  ds_read_b64_tr_b16 v[176:177], v204 offset:512
  ds_read_b64_tr_b16 v[178:179], v204 offset:2560
  v_exp_f32 v40, v40
  v_exp_f32 v41, v41
  v_exp_f32 v42, v42
  v_exp_f32 v43, v43
  v_smfmac_f32_32x32x32_bf16 v[128:143], v[184:187], v[32:39], v160
  s_waitcnt lgkmcnt(2)
  v_exp_f32 v44, v44
  v_exp_f32 v45, v45
  v_exp_f32 v46, v46
  v_exp_f32 v47, v47
  v_mfma_f32_32x32x4_2b_bf16 v[64:95], v[180:181], v[200:201], v[64:95] cbsz:1 abid:1
  ds_read_b64_tr_b16 v[180:181], v206 offset:512
  v_exp_f32 v48, v48
  v_exp_f32 v49, v49
  v_exp_f32 v50, v50
  v_exp_f32 v51, v51
  v_exp_f32 v52, v52
  v_exp_f32 v53, v53
  v_smfmac_f32_32x32x32_bf16 v[128:143], v[188:191], v[40:47], v160
  s_sub_u32 s0, s0, 1
  s_cbranch_scc1 .Lat_evp2
.Lat_bkp2:
  v_exp_f32 v54, v54
  v_exp_f32 v55, v55
  v_exp_f32 v56, v56
  v_exp_f32 v57, v57
  v_exp_f32 v58, v58
  v_smfmac_f32_32x32x32_bf16 v[144:159], v[184:187], v[48:55], v160
  s_waitcnt lgkmcnt(0)
  ds_read_b128 v[184:187], v207 offset:384
  v_exp_f32 v59, v59
  v_exp_f32 v60, v60
  v_exp_f32 v61, v61
  v_exp_f32 v62, v62
  v_exp_f32 v63, v63
  v_mfma_f32_32x32x16_bf16 v[32:47], v[176:179], v[192:195], 0
  v_exp_f32 v64, v64
  v_exp_f32 v65, v65
  v_exp_f32 v66, v66
  v_exp_f32 v67, v67
  v_smfmac_f32_32x32x32_bf16 v[144:159], v[188:191], v[56:63], v160
  s_waitcnt lgkmcnt(0)
  ds_read_b128 v[188:191], v207 offset:448
  v_exp_f32 v68, v68
  v_exp_f32 v69, v69
  v_exp_f32 v70, v70
  v_exp_f32 v71, v71
  v_mfma_f32_32x32x16_bf16 v[48:63], v[176:179], v[196:199], 0
  s_bitcmp1_b32 s30, s99
  s_cbranch_scc1 .Lat_eva
.Lat_bka:
  ds_read_b64_tr_b16 v[176:177], v205 offset:512
  ds_read_b64_tr_b16 v[178:179], v205 offset:2560
  v_exp_f32 v72, v72
  v_exp_f32 v73, v73
  v_exp_f32 v74, v74
  v_exp_f32 v75, v75
  v_smfmac_f32_32x32x32_bf16 v[128:143], v[184:187], v[64:71], v160
  s_waitcnt lgkmcnt(2)
  v_exp_f32 v76, v76
  v_exp_f32 v77, v77
  v_exp_f32 v78, v78
  v_exp_f32 v79, v79
  v_mfma_f32_32x32x4_2b_bf16 v[32:63], v[180:181], v[200:201], v[32:63] cbsz:1 abid:0
  v_exp_f32 v80, v80
  v_exp_f32 v81, v81
  v_exp_f32 v82, v82
  v_exp_f32 v83, v83
  v_exp_f32 v84, v84
  v_exp_f32 v85, v85
  v_smfmac_f32_32x32x32_bf16 v[128:143], v[188:191], v[72:79], v160
  s_sub_u32 s0, s0, 1
  s_cbranch_scc1 .Lat_evp3
.Lat_bkp3:
  v_exp_f32 v86, v86
  v_exp_f32 v87, v87
  v_exp_f32 v88, v88
  v_exp_f32 v89, v89
  v_exp_f32 v90, v90
  v_smfmac_f32_32x32x32_bf16 v[144:159], v[184:187], v[80:87], v160
  s_waitcnt lgkmcnt(0)
  ds_read_b128 v[184:187], v207 offset:512
  v_exp_f32 v91, v91
  v_exp_f32 v92, v92
  v_exp_f32 v93, v93
  v_exp_f32 v94, v94
  v_exp_f32 v95, v95
  v_mfma_f32_32x32x16_bf16 v[64:79], v[176:179], v[192:195], 0
  v_exp_f32 v32, v32
  v_exp_f32 v33, v33
  v_exp_f32 v34, v34
  v_exp_f32 v35, v35
  v_smfmac_f32_32x32x32_bf16 v[144:159], v[188:191], v[88:95], v160
  s_waitcnt lgkmcnt(0)
  ds_read_b128 v[188:191], v207 offset:576
  v_exp_f32 v36, v36
  v_exp_f32 v37, v37
  v_exp_f32 v38, v38
  v_exp_f32 v39, v39
  v_mfma_f32_32x32x16_bf16 v[80:95], v[176:179], v[196:199], 0
  ds_read_b64_tr_b16 v[176:177], v204 offset:768
  ds_read_b64_tr_b16 v[178:179], v204 offset:2816
  v_exp_f32 v40, v40
  v_exp_f32 v41, v41
  v_exp_f32 v42, v42
  v_exp_f32 v43, v43
  v_smfmac_f32_32x32x32_bf16 v[128:143], v[184:187], v[32:39], v160
  s_waitcnt lgkmcnt(2)
  v_exp_f32 v44, v44
  v_exp_f32 v45, v45
  v_exp_f32 v46, v46
  v_exp_f32 v47, v47
  v_mfma_f32_32x32x4_2b_bf16 v[64:95], v[180:181], v[200:201], v[64:95] cbsz:1 abid:1
  ds_read_b64_tr_b16 v[180:181], v206 offset:768
  v_exp_f32 v48, v48
  v_exp_f32 v49, v49
  v_exp_f32 v50, v50
  v_exp_f32 v51, v51
  v_exp_f32 v52, v52
  v_exp_f32 v53, v53
  v_smfmac_f32_32x32x32_bf16 v[128:143], v[188:191], v[40:47], v160
  v_exp_f32 v54, v54
  v_exp_f32 v55, v55
  v_exp_f32 v56, v56
  v_exp_f32 v57, v57
  v_exp_f32 v58, v58
  v_smfmac_f32_32x32x32_bf16 v[144:159], v[184:187], v[48:55], v160
  s_waitcnt lgkmcnt(0)
  ds_read_b128 v[184:187], v207 offset:640
  v_exp_f32 v59, v59
  v_exp_f32 v60, v60
  v_exp_f32 v61, v61
  v_exp_f32 v62, v62
  v_exp_f32 v63, v63
  v_mfma_f32_32x32x16_bf16 v[32:47], v[176:179], v[192:195], 0
  v_exp_f32 v64, v64
  v_exp_f32 v65, v65
  v_exp_f32 v66, v66
  v_exp_f32 v67, v67
  v_smfmac_f32_32x32x32_bf16 v[144:159], v[188:191], v[56:63], v160
  s_waitcnt lgkmcnt(0)
  ds_read_b128 v[188:191], v207 offset:704
  v_exp_f32 v68, v68
  v_exp_f32 v69, v69
  v_exp_f32 v70, v70
  v_exp_f32 v71, v71
  v_mfma_f32_32x32x16_bf16 v[48:63], v[176:179], v[196:199], 0
  ds_read_b64_tr_b16 v[176:177], v205 offset:768
  ds_read_b64_tr_b16 v[178:179], v205 offset:2816
  v_exp_f32 v72, v72
  v_exp_f32 v73, v73
  v_exp_f32 v74, v74
  v_exp_f32 v75, v75
  v_smfmac_f32_32x32x32_bf16 v[128:143], v[184:187], v[64:71], v160
  s_waitcnt lgkmcnt(2)
  v_exp_f32 v76, v76
  v_exp_f32 v77, v77
  v_exp_f32 v78, v78
  v_exp_f32 v79, v79
  v_mfma_f32_32x32x4_2b_bf16 v[32:63], v[180:181], v[200:201], v[32:63] cbsz:1 abid:0
  v_exp_f32 v80, v80
  v_exp_f32 v81, v81
  v_exp_f32 v82, v82
  v_exp_f32 v83, v83
  v_exp_f32 v84, v84
  v_exp_f32 v85, v85
  v_smfmac_f32_32x32x32_bf16 v[128:143], v[188:191], v[72:79], v160
  s_sub_u32 s0, s0, 1
  s_cbranch_scc1 .Lat_evp5
.Lat_bkp5:
  v_exp_f32 v86, v86
  v_exp_f32 v87, v87
  v_exp_f32 v88, v88
  v_exp_f32 v89, v89
  v_exp_f32 v90, v90
  v_smfmac_f32_32x32x32_bf16 v[144:159], v[184:187], v[80:87], v160
  s_waitcnt lgkmcnt(0)
  ds_read_b128 v[184:187], v207 offset:768
  v_exp_f32 v91, v91
  v_exp_f32 v92, v92
  v_exp_f32 v93, v93
  v_exp_f32 v94, v94
  v_exp_f32 v95, v95
  v_mfma_f32_32x32x16_bf16 v[64:79], v[176:179], v[192:195], 0
  v_exp_f32 v32, v32
  v_exp_f32 v33, v33
  v_exp_f32 v34, v34
  v_exp_f32 v35, v35
  v_smfmac_f32_32x32x32_bf16 v[144:159], v[188:191], v[88:95], v160
  s_waitcnt lgkmcnt(0)
  ds_read_b128 v[188:191], v207 offset:832
  v_exp_f32 v36, v36
  v_exp_f32 v37, v37
  v_exp_f32 v38, v38
  v_exp_f32 v39, v39
  v_mfma_f32_32x32x16_bf16 v[80:95], v[176:179], v[196:199], 0
  s_bitcmp1_b32 s31, s99
  s_cbranch_scc1 .Lat_evb
.Lat_bkb:
  v_add_u32 v204, s70, v204
  ds_read_b64_tr_b16 v[176:177], v204 offset:0
  ds_read_b64_tr_b16 v[178:179], v204 offset:2048
  v_exp_f32 v40, v40
  v_exp_f32 v41, v41
  v_exp_f32 v42, v42
  v_exp_f32 v43, v43
  v_smfmac_f32_32x32x32_bf16 v[128:143], v[184:187], v[32:39], v160
  s_waitcnt lgkmcnt(2)
  v_exp_f32 v44, v44
  v_exp_f32 v45, v45
  v_exp_f32 v46, v46
  v_exp_f32 v47, v47
  v_mfma_f32_32x32x4_2b_bf16 v[64:95], v[180:181], v[200:201], v[64:95] cbsz:1 abid:1
  v_mad_u32_u24 v206, v203, s70, v206
  ds_read_b64_tr_b16 v[180:181], v206 offset:0
  v_exp_f32 v48, v48
  v_exp_f32 v49, v49
  v_exp_f32 v50, v50
  v_exp_f32 v51, v51
  v_exp_f32 v52, v52
  v_exp_f32 v53, v53
  v_smfmac_f32_32x32x32_bf16 v[128:143], v[188:191], v[40:47], v160
  v_exp_f32 v54, v54
  v_exp_f32 v55, v55
  v_exp_f32 v56, v56
  v_exp_f32 v57, v57
  v_exp_f32 v58, v58
  v_smfmac_f32_32x32x32_bf16 v[144:159], v[184:187], v[48:55], v160
  s_waitcnt lgkmcnt(0)
  ds_read_b128 v[184:187], v207 offset:896
  v_exp_f32 v59, v59
  v_exp_f32 v60, v60
  v_exp_f32 v61, v61
  v_exp_f32 v62, v62
  v_exp_f32 v63, v63
  v_mfma_f32_32x32x16_bf16 v[32:47], v[176:179], v[192:195], 0
  v_exp_f32 v64, v64
  v_exp_f32 v65, v65
  v_exp_f32 v66, v66
  v_exp_f32 v67, v67
  v_smfmac_f32_32x32x32_bf16 v[144:159], v[188:191], v[56:63], v160
  s_waitcnt lgkmcnt(0)
  ds_read_b128 v[188:191], v207 offset:960
  v_exp_f32 v68, v68
  v_exp_f32 v69, v69
  v_exp_f32 v70, v70
  v_exp_f32 v71, v71
  v_mfma_f32_32x32x16_bf16 v[48:63], v[176:179], v[196:199], 0
  v_add_u32 v205, s70, v205
  ds_read_b64_tr_b16 v[176:177], v205 offset:0
  ds_read_b64_tr_b16 v[178:179], v205 offset:2048
  v_exp_f32 v72, v72
  v_exp_f32 v73, v73
  v_exp_f32 v74, v74
  v_exp_f32 v75, v75
  v_smfmac_f32_32x32x32_bf16 v[128:143], v[184:187], v[64:71], v160
  s_waitcnt lgkmcnt(2)
  v_exp_f32 v76, v76
  v_exp_f32 v77, v77
  v_exp_f32 v78, v78
  v_exp_f32 v79, v79
  v_mfma_f32_32x32x4_2b_bf16 v[32:63], v[180:181], v[200:201], v[32:63] cbsz:1 abid:0
  v_exp_f32 v80, v80
  v_exp_f32 v81, v81
  v_exp_f32 v82, v82
  v_exp_f32 v83, v83
  v_exp_f32 v84, v84
  v_exp_f32 v85, v85
  v_smfmac_f32_32x32x32_bf16 v[128:143], v[188:191], v[72:79], v160
  v_mad_u32_u24 v207, v208, s70, v207
  v_exp_f32 v86, v86
  v_exp_f32 v87, v87
  v_exp_f32 v88, v88
  v_exp_f32 v89, v89
  v_exp_f32 v90, v90
  v_smfmac_f32_32x32x32_bf16 v[144:159], v[184:187], v[80:87], v160
  s_waitcnt lgkmcnt(0)
  ds_read_b128 v[184:187], v207 offset:0
  s_and_b32 s70, s72, 15
  s_lshr_b32 s72, s72, 4
  s_mul_i32 s70, s70, 18720
  s_add_u32 s99, s99, 1
  s_cmp_lt_u32 s99, 4
  v_exp_f32 v91, v91
  v_exp_f32 v92, v92
  v_exp_f32 v93, v93
  v_exp_f32 v94, v94
  v_exp_f32 v95, v95
  s_cbranch_scc1 .Lat_loop
  s_nop 0
  v_smfmac_f32_32x32x32_bf16 v[144:159], v[188:191], v[88:95], v160
  s_setprio 0
  s_cmp_lg_u32 s96, 0
  s_cbranch_scc1 .Lat_x1
  ds_write_b128 v20, v[128:131] offset:0
  ds_write_b128 v20, v[132:135] offset:1024
  s_mov_b32 exec_hi, 0
  ds_write_b128 v20, v[136:139] offset:2048
  s_mov_b32 exec_hi, -1
  s_nop 3
  ds_write_b128 v20, v[144:147] offset:2560
  ds_write_b128 v20, v[148:151] offset:3584
  s_mov_b32 exec_hi, 0
  ds_write_b128 v20, v[152:155] offset:4608
  s_mov_b32 exec_lo, 1
  s_waitcnt vmcnt(0)
  ds_write_b32 v22, v23
  ds_add_u32 v21, v23
  s_mov_b64 exec, -1
  s_mov_b32 s70, 0
  s_mov_b32 s78, 0
  s_lshl_b32 s73, s97, 14
  s_add_u32 s73, s73, 73728
  s_mov_b32 s71, 0x55
  s_mov_b32 s82, 0
  s_mov_b32 s83, 0
  s_lshl_b32 s74, s97, 19
  s_lshl_b32 s79, s94, 10
  s_add_u32 s74, s74, s79
  s_add_u32 s74, s74, 9961472
  s_lshl_b32 s76, s97, 11
  s_add_u32 s76, s76, 139264
  s_lshl_b32 s77, s97, 16
  s_lshl_b32 s79, s94, 8
  s_add_u32 s77, s77, s79
  s_add_u32 s77, s77, 12058624
  v_and_b32 v19, 0x1ff, v2
  v_add_u32 v19, s76, v19
  v_and_b32 v18, 0xff, v2
  v_lshrrev_b32 v21, 4, v0
  v_lshl_add_u32 v21, v21, 13, v18
  v_add_u32 v18, s73, v2
  s_add_u32 s79, s97, 162928
  v_mov_b32 v26, s79
  s_lshl_b32 s79, s97, 1
  s_lshr_b32 s80, s94, 2
  s_cmp_eq_u32 s79, s80
  s_cselect_b32 s30, 4, 0
  v_mov_b32 v12, 162872
.Lfc_36:
  ds_read_b64 v[8:9], v12
  s_waitcnt lgkmcnt(0)
  v_readfirstlane_b32 s79, v8
  v_readfirstlane_b32 s80, v9
  s_cmp_lt_u32 s79, 8
  s_cbranch_scc1 .Lfc_36
  s_cmp_lg_u32 s80, 0
  s_cbranch_scc1 .Lat_redo
  s_setprio 1
.Lg_fill:
  s_ff1_i32_b32 s79, s71
  s_bitset0_b32 s71, s79
  s_xor_b32 s79, s79, s30
  s_lshl_b32 s80, s79, 11
  s_add_u32 m0, s80, s73
  s_lshl_b32 s80, s79, 16
  s_add_u32 s80, s80, s74
  buffer_load_dwordx4 v2, s[4:7], s80 offen sc1 lds
  s_add_u32 m0, m0, 1024
  s_add_u32 s80, s80, 32768
  buffer_load_dwordx4 v2, s[4:7], s80 offen sc1 lds
  s_add_u32 m0, m0, 1024
  s_add_u32 s80, s80, 32768
  buffer_load_dwordx4 v2, s[4:7], s80 offen sc1 lds
  s_add_u32 m0, m0, 1024
  s_add_u32 s80, s80, 32768
  buffer_load_dwordx4 v2, s[4:7], s80 offen sc1 lds
  s_lshl_b32 s80, s79, 8
  s_add_u32 m0, s80, s76
  s_lshl_b32 s80, s79, 13
  s_add_u32 s80, s80, s77
  s_mov_b32 exec_hi, 0
  buffer_load_dwordx4 v21, s[4:7], s80 offen sc1 lds
  s_mov_b32 exec_hi, -1
  s_lshl_b32 s79, s79, s83
  s_or_b32 s82, s82, s79
  s_add_u32 s83, s83, 4
.Lg_next:
  s_cmp_lt_u32 s83, 8
  s_cselect_b32 s79, s71, 0
  s_cmp_lg_u32 s79, 0
  s_cbranch_scc1 .Lg_fill
  s_cmp_eq_u32 s78, 0
  s_cbranch_scc1 .Lg_first
.Lg_back:
  s_and_b32 s79, s82, 15
  v_lshl_add_u32 v4, s79, 11, v18
  v_lshl_add_u32 v5, s79, 8, v19
  s_lshr_b32 s82, s82, 4
  s_sub_u32 s83, s83, 4
  s_waitcnt vmcnt(5)
  s_cmp_ge_u32 s83, 4
  s_cbranch_scc1 .Lg_w
  s_waitcnt vmcnt(0)
.Lg_w:
  ds_read2st64_b32 v[6:7], v4 offset1:4
  ds_read2st64_b32 v[8:9], v4 offset0:8 offset1:12
  ds_read_b32 v10, v5
  s_add_u32 s78, s78, 1
  s_waitcnt lgkmcnt(1)
  v_max3_u32 v6, v6, v7, v8
  s_waitcnt lgkmcnt(0)
  v_max3_u32 v6, v6, v9, v10
  v_cmp_eq_u32 vcc, -1, v6
  s_cbranch_vccnz .Lg_bad
.Lg_good:
  s_bitset1_b32 s70, s79
  v_mov_b32 v27, s70
  ds_write_b8 v26, v27
  s_cmp_eq_u32 s70, 0x55
  s_cbranch_scc0 .Lg_next
  s_branch .Lp3_nar
.Lg_bad:
  s_cmp_ge_u32 s78, 65536
  s_cbranch_scc1 .Lg_good
  s_xor_b32 s79, s79, s30
  s_bitset1_b32 s71, s79
  s_branch .Lg_next
.Lg_first:
  v_mfma_f32_32x32x16_bf16 v[48:63], v[96:99], v[218:221], 0
  v_mfma_f32_32x32x16_bf16 v[48:63], v[100:103], v[222:225], v[48:63]
  v_mfma_f32_32x32x16_bf16 v[48:63], v[104:107], v[226:229], v[48:63]
  v_mfma_f32_32x32x16_bf16 v[48:63], v[108:111], v[230:233], v[48:63]
  v_mfma_f32_32x32x16_bf16 v[48:63], v[112:115], v[234:237], v[48:63]
  v_mfma_f32_32x32x16_bf16 v[48:63], v[116:119], v[238:241], v[48:63]
  v_mfma_f32_32x32x16_bf16 v[48:63], v[120:123], v[242:245], v[48:63]
  v_mfma_f32_32x32x16_bf16 v[48:63], v[124:127], v[246:249], v[48:63]
  s_nop 7
  s_nop 3
  v_cvt_pk_bf16_f32 v80, v48, v49
  v_cvt_pk_bf16_f32 v81, v50, v51
  v_cvt_pk_bf16_f32 v82, v52, v53
  v_cvt_pk_bf16_f32 v83, v54, v55
  v_cvt_pk_bf16_f32 v84, v56, v57
  v_cvt_pk_bf16_f32 v85, v58, v59
  v_cvt_pk_bf16_f32 v86, v60, v61
  v_cvt_pk_bf16_f32 v87, v62, v63
  v_lshrrev_b32 v8, 4, v0
  v_bfe_u32 v9, v0, 2, 2
  v_bfe_u32 v10, v0, 3, 1
  v_and_b32 v11, 1, v0
  v_lshlrev_b32 v11, 3, v11
  v_add_u32 v11, 149760, v11
  v_lshrrev_b32 v3, 5, v0
  v_mul_u32_u24 v3, 18, v3
  v_and_b32 v4, 1, v8
  v_lshl_add_u32 v3, v4, 2, v3
  v_add_u32 v3, v3, v9
  v_lshl_add_u32 v3, v3, 4, v11
  v_lshl_add_u32 v4, v8, 2, v10
  v_mul_u32_u24 v4, 18, v4
  v_and_b32 v9, 1, v9
  v_add3_u32 v4, v4, v9, 16
  v_lshl_add_u32 v12, v4, 4, v11
  ds_read_b64_tr_b16 v[88:89], v3 offset:0
  ds_read_b64_tr_b16 v[90:91], v3 offset:128
  ds_read_b64_tr_b16 v[92:93], v3 offset:576
  ds_read_b64_tr_b16 v[94:95], v3 offset:704
  ds_read_b64_tr_b16 v[96:97], v3 offset:1152
  ds_read_b64_tr_b16 v[98:99], v3 offset:1280
  ds_read_b64_tr_b16 v[100:101], v3 offset:1728
  ds_read_b64_tr_b16 v[102:103], v3 offset:1856
  ds_read_b64_tr_b16 v[104:105], v3 offset:2304
  ds_read_b64_tr_b16 v[106:107], v3 offset:2432
  ds_read_b64_tr_b16 v[108:109], v3 offset:2880
  ds_read_b64_tr_b16 v[110:111], v3 offset:3008
  ds_read_b64_tr_b16 v[112:113], v3 offset:3456
  ds_read_b64_tr_b16 v[114:115], v3 offset:3584
  s_waitcnt lgkmcnt(13)
  ds_read_b64_tr_b16 v[116:117], v3 offset:4032
  ds_read_b64_tr_b16 v[118:119], v3 offset:4160
  s_waitcnt lgkmcnt(13)
  ds_read_b64_tr_b16 v[120:121], v3 offset:4608
  ds_read_b64_tr_b16 v[122:123], v3 offset:4736
  s_waitcnt lgkmcnt(13)
  ds_read_b64_tr_b16 v[124:125], v3 offset:5184
  ds_read_b64_tr_b16 v[126:127], v3 offset:5312
  s_waitcnt lgkmcnt(13)
  ds_read_b64_tr_b16 v[128:129], v3 offset:5760
  ds_read_b64_tr_b16 v[130:131], v3 offset:5888
  s_waitcnt lgkmcnt(13)
  ds_read_b64_tr_b16 v[132:133], v3 offset:6336
  ds_read_b64_tr_b16 v[134:135], v3 offset:6464
  s_waitcnt lgkmcnt(13)
  ds_read_b64_tr_b16 v[136:137], v3 offset:6912
  ds_read_b64_tr_b16 v[138:139], v3 offset:7040
  s_waitcnt lgkmcnt(13)
  ds_read_b64_tr_b16 v[140:141], v3 offset:7488
  ds_read_b64_tr_b16 v[142:143], v3 offset:7616
  s_waitcnt lgkmcnt(13)
  ds_read_b64_tr_b16 v[144:145], v3 offset:8064
  ds_read_b64_tr_b16 v[146:147], v3 offset:8192
  s_waitcnt lgkmcnt(13)
  ds_read_b64_tr_b16 v[148:149], v3 offset:8640
  ds_read_b64_tr_b16 v[150:151], v3 offset:8768
  s_waitcnt lgkmcnt(13)
  ds_read_b64_tr_b16 v[152:153], v12 offset:0
  ds_read_b64_tr_b16 v[154:155], v12 offset:576
  s_waitcnt lgkmcnt(13)
  ds_read_b64_tr_b16 v[156:157], v12 offset:4608
  ds_read_b64_tr_b16 v[158:159], v12 offset:5184
  v_and_b32 v3, 15, v0
  v_lshrrev_b32 v4, 4, v0
  s_mov_b32 s75, 0
  v_lshlrev_b32 v23, 4, v3
  v_lshl_add_u32 v23, v4, 10, v23
  s_lshl_b32 s79, s97, 8
  s_add_u32 s79, s79, 73728
  v_add_u32 v23, s79, v23
  s_lshl_b32 s79, s97, 6
  s_add_u32 s79, s79, 139264
  v_lshlrev_b32 v24, 2, v3
  v_lshl_add_u32 v24, v4, 10, v24
  v_add_u32 v24, s79, v24
  s_lshl_b32 s79, s94, 6
  s_lshl_b32 s80, s97, 4
  s_add_u32 s79, s79, s80
  v_add_u32 v25, s79, v3
  v_mul_u32_u24 v25, 2304, v25
  v_lshl_add_u32 v25, v4, 3, v25
  s_lshl_b32 s72, s95, 4
  s_add_u32 s72, s72, 2176
  s_branch .Lg_back
.Lat_x1:
  s_mul_i32 s80, s97, 5120
  s_add_u32 s80, s80, 74880
  v_lshlrev_b32 v2, 4, v0
  v_add_u32 v20, s80, v2
  s_lshl_b32 s80, s97, 2
  s_add_u32 s80, s80, 162880
  v_mov_b32 v22, s80
  v_mov_b32 v23, 1
  v_mov_b32 v21, 162872
  s_lshl_b32 s80, s95, 8
  s_lshl_b32 s81, s97, 6
  s_add_u32 s80, s80, s81
  v_and_b32 v18, 31, v0
  v_add_u32 v18, s80, v18
  v_lshlrev_b32 v19, 4, v18
  v_lshlrev_b32 v18, 2, v18
  v_lshrrev_b32 v26, 5, v0
  v_lshl_add_u32 v19, v26, 15, v19
  s_lshl_b32 s70, s94, 16
  s_add_u32 s70, s70, 9961472
  s_lshl_b32 s72, s94, 13
  s_add_u32 s72, s72, 12058624
  v_mov_b32 v8, 0x7e000000
  s_setprio 0
.Lxs_37:
  ds_read_b32 v11, v22
  ds_read_b128 v[64:67], v20 offset:0
  ds_read_b128 v[68:71], v20 offset:1024
  ds_read_b128 v[80:83], v20 offset:2560
  ds_read_b128 v[84:87], v20 offset:3584
  ds_read_b128 v[72:75], v20 offset:2048
  ds_read_b128 v[88:91], v20 offset:4608
  s_waitcnt lgkmcnt(6)
  v_readfirstlane_b32 s79, v11
  s_cmp_eq_u32 s79, 0
  s_cbranch_scc1 .Lxs_37
  s_setprio 2
  s_waitcnt lgkmcnt(4)
  v_pk_add_f32 v[128:129], v[128:129], v[64:65]
  v_pk_add_f32 v[130:131], v[130:131], v[66:67]
  v_pk_add_f32 v[132:133], v[132:133], v[68:69]
  v_pk_add_f32 v[134:135], v[134:135], v[70:71]
  s_waitcnt lgkmcnt(2)
  v_pk_add_f32 v[144:145], v[144:145], v[80:81]
  v_pk_add_f32 v[146:147], v[146:147], v[82:83]
  v_pk_add_f32 v[148:149], v[148:149], v[84:85]
  v_pk_add_f32 v[150:151], v[150:151], v[86:87]
  s_waitcnt lgkmcnt(0)
  s_mov_b64 exec, 0xffffffff
  v_pk_add_f32 v[136:137], v[136:137], v[72:73]
  v_add_f32 v138, v138, v74
  v_pk_add_f32 v[152:153], v[152:153], v[88:89]
  v_add_f32 v154, v154, v90
  s_mov_b64 exec, -1
  s_cmp_lg_u32 s98, 0
  s_cbranch_scc1 .Lok_38
  v_maximum3_f32 v12, |v128|, |v129|, |v130|
  v_maximum3_f32 v4, |v144|, |v145|, |v146|
  v_maximum3_f32 v12, v12, |v131|, |v132|
  v_maximum3_f32 v4, v4, |v147|, |v148|
  v_maximum3_f32 v12, v12, |v133|, |v134|
  v_maximum3_f32 v4, v4, |v149|, |v150|
  v_maximum3_f32 v12, v12, |v135|, |v136|
  v_maximum3_f32 v4, v4, |v151|, |v152|
  v_maximum3_f32 v12, v12, |v137|, |v138|
  v_maximum3_f32 v4, v4, |v153|, |v154|
  v_maximum3_f32 v12, v12, v4, v4
  v_cmp_nlt_f32 vcc, v12, v8
  s_cbranch_vccz .Lok_38
  ds_write_b32 v21, v23 offset:4
  s_mov_b64 exec, 1
  s_waitcnt vmcnt(0)
  ds_add_u32 v21, v23
  s_mov_b64 exec, -1
  s_branch .Lat_x1e
.Lok_38:
  v_mov_b32 v12, v138
  v_mov_b32 v4, v154
  s_mov_b64 exec, 1
  ds_add_u32 v21, v23
  s_mov_b64 exec, -1
  v_permlane32_swap_b32 v138, v12
  v_permlane32_swap_b32 v154, v4
  s_nop 0
  v_rcp_f32 v12, v138
  v_rcp_f32 v4, v154
  v_pk_mul_f32 v[128:129], v[128:129], v[12:13] op_sel_hi:[1,0]
  v_pk_mul_f32 v[130:131], v[130:131], v[12:13] op_sel_hi:[1,0]
  v_pk_mul_f32 v[132:133], v[132:133], v[12:13] op_sel_hi:[1,0]
  v_pk_mul_f32 v[134:135], v[134:135], v[12:13] op_sel_hi:[1,0]
  v_pk_mul_f32 v[136:137], v[136:137], v[12:13] op_sel_hi:[1,0]
  v_cvt_pk_bf16_f32 v36, v136, v137
  v_cvt_pk_bf16_f32 v32, v128, v129
  v_cvt_pk_bf16_f32 v33, v130, v131
  v_cvt_pk_bf16_f32 v34, v132, v133
  v_cvt_pk_bf16_f32 v35, v134, v135
  buffer_store_dwordx4 v[32:35], v19, s[4:7], s70 offen offset:0 sc1
  v_mov_b32_dpp v37, v36 quad_perm:[1,1,1,1] row_mask:0xf bank_mask:0xf
  v_mov_b32_dpp v38, v36 quad_perm:[2,2,2,2] row_mask:0xf bank_mask:0xf
  v_mov_b32_dpp v39, v36 quad_perm:[3,3,3,3] row_mask:0xf bank_mask:0xf
  v_pk_mul_f32 v[144:145], v[144:145], v[4:5] op_sel_hi:[1,0]
  v_pk_mul_f32 v[146:147], v[146:147], v[4:5] op_sel_hi:[1,0]
  v_pk_mul_f32 v[148:149], v[148:149], v[4:5] op_sel_hi:[1,0]
  v_pk_mul_f32 v[150:151], v[150:151], v[4:5] op_sel_hi:[1,0]
  v_pk_mul_f32 v[152:153], v[152:153], v[4:5] op_sel_hi:[1,0]
  v_cvt_pk_bf16_f32 v44, v152, v153
  v_cvt_pk_bf16_f32 v40, v144, v145
  v_cvt_pk_bf16_f32 v41, v146, v147
  v_cvt_pk_bf16_f32 v42, v148, v149
  v_cvt_pk_bf16_f32 v43, v150, v151
  buffer_store_dwordx4 v[40:43], v19, s[4:7], s70 offen offset:512 sc1
  v_mov_b32_dpp v45, v44 quad_perm:[1,1,1,1] row_mask:0xf bank_mask:0xf
  v_mov_b32_dpp v46, v44 quad_perm:[2,2,2,2] row_mask:0xf bank_mask:0xf
  v_mov_b32_dpp v47, v44 quad_perm:[3,3,3,3] row_mask:0xf bank_mask:0xf
  s_mov_b64 exec, 0x11111111
  buffer_store_dwordx4 v[36:39], v18, s[4:7], s72 offen sc1
  buffer_store_dwordx4 v[44:47], v18, s[4:7], s72 offen offset:128 sc1
  s_mov_b64 exec, -1
.Lat_x1e:
  s_setprio 0
  s_cmp_eq_u32 s1, 0
  s_cbranch_scc1 .Lat_nosb1
  s_cmp_lg_u32 s98, 0
  s_cbranch_scc1 .Lat_nosb1
  s_waitcnt vmcnt(4)
  v_mfma_f32_32x32x16_bf16 v[48:63], v[96:99], v[218:221], 0
  v_mfma_f32_32x32x16_bf16 v[48:63], v[100:103], v[222:225], v[48:63]
  v_mfma_f32_32x32x16_bf16 v[48:63], v[104:107], v[226:229], v[48:63]
  v_mfma_f32_32x32x16_bf16 v[48:63], v[108:111], v[230:233], v[48:63]
  v_mfma_f32_32x32x16_bf16 v[48:63], v[112:115], v[234:237], v[48:63]
  v_mfma_f32_32x32x16_bf16 v[48:63], v[116:119], v[238:241], v[48:63]
  v_mfma_f32_32x32x16_bf16 v[48:63], v[120:123], v[242:245], v[48:63]
  v_mfma_f32_32x32x16_bf16 v[48:63], v[124:127], v[246:249], v[48:63]
  s_nop 7
  s_nop 3
  v_cvt_pk_bf16_f32 v80, v48, v49
  v_cvt_pk_bf16_f32 v81, v50, v51
  v_cvt_pk_bf16_f32 v82, v52, v53
  v_cvt_pk_bf16_f32 v83, v54, v55
  v_cvt_pk_bf16_f32 v84, v56, v57
  v_cvt_pk_bf16_f32 v85, v58, v59
  v_cvt_pk_bf16_f32 v86, v60, v61
  v_cvt_pk_bf16_f32 v87, v62, v63
  buffer_store_dwordx4 v[80:83], v161, s[64:67], 0 offen
  buffer_store_dwordx4 v[84:87], v161, s[64:67], 0 offen offset:32
.Lat_nosb1:
  v_mov_b32 v12, 162872
.Lfc_39:
  ds_read_b64 v[8:9], v12
  s_waitcnt lgkmcnt(0)
  v_readfirstlane_b32 s79, v8
  v_readfirstlane_b32 s80, v9
  s_cmp_lt_u32 s79, 8
  s_cbranch_scc1 .Lfc_39
  s_cmp_lg_u32 s80, 0
  s_cbranch_scc1 .Lat_redo
  v_lshrrev_b32 v8, 5, v0
  v_bfe_u32 v9, v0, 2, 2
  v_bfe_u32 v10, v0, 3, 1
  s_and_b32 s79, s97, 1
  s_lshl_b32 s79, s79, 2
  v_lshlrev_b32 v11, 2, v10
  v_xor_b32 v11, s79, v11
  v_bfe_u32 v12, v0, 4, 1
  v_lshl_add_u32 v11, v12, 1, v11
  v_and_b32 v12, 1, v0
  v_add_u32 v11, v11, v12
  v_lshlrev_b32 v11, 4, v11
  v_and_b32 v12, 2, v0
  v_lshl_add_u32 v11, v12, 2, v11
  v_mul_u32_u24 v12, 72, v8
  v_mul_u32_u24 v13, 18, v10
  v_add_u32 v12, v12, v13
  v_and_b32 v13, 1, v9
  v_add3_u32 v12, v12, v13, 16
  v_lshl_add_u32 v12, v12, 7, v11
  v_lshl_add_u32 v8, v8, 2, v9
  v_lshl_add_u32 v8, v8, 7, v11
  v_xor_b32 v9, 64, v8
  v_add_u32 v10, 55296, v8
  v_add_u32 v11, 55296, v9
  ds_read_b64_tr_b16 v[64:65], v8 offset:0
  ds_read_b64_tr_b16 v[66:67], v8 offset:1024
  ds_read_b64_tr_b16 v[68:69], v9 offset:2304
  ds_read_b64_tr_b16 v[70:71], v9 offset:3328
  ds_read_b64_tr_b16 v[72:73], v8 offset:4608
  ds_read_b64_tr_b16 v[74:75], v8 offset:5632
  ds_read_b64_tr_b16 v[76:77], v9 offset:6912
  ds_read_b64_tr_b16 v[78:79], v9 offset:7936
  ds_read_b64_tr_b16 v[80:81], v8 offset:9216
  ds_read_b64_tr_b16 v[82:83], v8 offset:10240
  ds_read_b64_tr_b16 v[84:85], v9 offset:11520
  ds_read_b64_tr_b16 v[86:87], v9 offset:12544
  ds_read_b64_tr_b16 v[88:89], v8 offset:13824
  ds_read_b64_tr_b16 v[90:91], v8 offset:14848
  s_waitcnt lgkmcnt(13)
  ds_read_b64_tr_b16 v[92:93], v9 offset:16128
  ds_read_b64_tr_b16 v[94:95], v9 offset:17152
  s_waitcnt lgkmcnt(13)
  ds_read_b64_tr_b16 v[96:97], v8 offset:18432
  ds_read_b64_tr_b16 v[98:99], v8 offset:19456
  s_waitcnt lgkmcnt(13)
  ds_read_b64_tr_b16 v[100:101], v9 offset:20736
  ds_read_b64_tr_b16 v[102:103], v9 offset:21760
  s_waitcnt lgkmcnt(13)
  ds_read_b64_tr_b16 v[104:105], v8 offset:23040
  ds_read_b64_tr_b16 v[106:107], v8 offset:24064
  s_waitcnt lgkmcnt(13)
  ds_read_b64_tr_b16 v[108:109], v9 offset:25344
  ds_read_b64_tr_b16 v[110:111], v9 offset:26368
  s_waitcnt lgkmcnt(13)
  ds_read_b64_tr_b16 v[112:113], v8 offset:27648
  ds_read_b64_tr_b16 v[114:115], v8 offset:28672
  s_waitcnt lgkmcnt(13)
  ds_read_b64_tr_b16 v[116:117], v9 offset:29952
  ds_read_b64_tr_b16 v[118:119], v9 offset:30976
  s_waitcnt lgkmcnt(13)
  ds_read_b64_tr_b16 v[120:121], v8 offset:32256
  ds_read_b64_tr_b16 v[122:123], v8 offset:33280
  s_waitcnt lgkmcnt(13)
  ds_read_b64_tr_b16 v[124:125], v9 offset:34560
  ds_read_b64_tr_b16 v[126:127], v9 offset:35584
  s_waitcnt lgkmcnt(13)
  ds_read_b64_tr_b16 v[128:129], v8 offset:36864
  ds_read_b64_tr_b16 v[130:131], v8 offset:37888
  s_waitcnt lgkmcnt(13)
  ds_read_b64_tr_b16 v[132:133], v9 offset:39168
  ds_read_b64_tr_b16 v[134:135], v9 offset:40192
  s_waitcnt lgkmcnt(13)
  ds_read_b64_tr_b16 v[136:137], v8 offset:41472
  ds_read_b64_tr_b16 v[138:139], v8 offset:42496
  s_waitcnt lgkmcnt(13)
  ds_read_b64_tr_b16 v[140:141], v9 offset:43776
  ds_read_b64_tr_b16 v[142:143], v9 offset:44800
  s_waitcnt lgkmcnt(13)
  ds_read_b64_tr_b16 v[144:145], v8 offset:46080
  ds_read_b64_tr_b16 v[146:147], v8 offset:47104
  s_waitcnt lgkmcnt(13)
  ds_read_b64_tr_b16 v[148:149], v9 offset:48384
  ds_read_b64_tr_b16 v[150:151], v9 offset:49408
  s_waitcnt lgkmcnt(13)
  ds_read_b64_tr_b16 v[152:153], v8 offset:50688
  ds_read_b64_tr_b16 v[154:155], v8 offset:51712
  s_waitcnt lgkmcnt(13)
  ds_read_b64_tr_b16 v[156:157], v9 offset:52992
  ds_read_b64_tr_b16 v[158:159], v9 offset:54016
  s_waitcnt lgkmcnt(13)
  ds_read_b64_tr_b16 v[160:161], v10 offset:0
  ds_read_b64_tr_b16 v[162:163], v10 offset:1024
  s_waitcnt lgkmcnt(13)
  ds_read_b64_tr_b16 v[164:165], v11 offset:2304
  ds_read_b64_tr_b16 v[166:167], v11 offset:3328
  s_waitcnt lgkmcnt(13)
  ds_read_b64_tr_b16 v[168:169], v10 offset:4608
  ds_read_b64_tr_b16 v[170:171], v10 offset:5632
  s_waitcnt lgkmcnt(13)
  ds_read_b64_tr_b16 v[172:173], v11 offset:6912
  ds_read_b64_tr_b16 v[174:175], v11 offset:7936
  s_waitcnt lgkmcnt(13)
  ds_read_b64_tr_b16 v[176:177], v10 offset:9216
  ds_read_b64_tr_b16 v[178:179], v10 offset:10240
  s_waitcnt lgkmcnt(13)
  ds_read_b64_tr_b16 v[180:181], v11 offset:11520
  ds_read_b64_tr_b16 v[182:183], v11 offset:12544
  s_waitcnt lgkmcnt(13)
  ds_read_b64_tr_b16 v[184:185], v10 offset:13824
  ds_read_b64_tr_b16 v[186:187], v10 offset:14848
  s_waitcnt lgkmcnt(13)
  ds_read_b64_tr_b16 v[188:189], v11 offset:16128
  ds_read_b64_tr_b16 v[190:191], v11 offset:17152
  s_waitcnt lgkmcnt(13)
  ds_read_b64_tr_b16 v[192:193], v12 offset:0
  ds_read_b64_tr_b16 v[194:195], v12 offset:4608
  s_waitcnt lgkmcnt(13)
  ds_read_b64_tr_b16 v[196:197], v12 offset:18432
  ds_read_b64_tr_b16 v[198:199], v12 offset:23040
  s_waitcnt lgkmcnt(13)
  ds_read_b64_tr_b16 v[200:201], v12 offset:36864
  ds_read_b64_tr_b16 v[202:203], v12 offset:41472
  s_waitcnt lgkmcnt(13)
  ds_read_b64_tr_b16 v[204:205], v12 offset:55296
  ds_read_b64_tr_b16 v[206:207], v12 offset:59904
  s_and_b32 s70, s97, 1
  s_lshr_b32 s71, s97, 1
  s_mov_b32 s75, 0
  v_and_b32 v5, 31, v0
  v_lshrrev_b32 v6, 5, v0
  v_lshlrev_b32 v4, 4, v5
  v_lshl_add_u32 v4, v6, 10, v4
  s_lshl_b32 s72, s71, 9
  s_add_u32 s72, s72, 73728
  v_add_u32 v4, s72, v4
  s_lshl_b32 s72, s71, 7
  s_add_u32 s72, s72, 139264
  v_lshlrev_b32 v15, 2, v5
  v_lshl_add_u32 v15, v6, 10, v15
  v_add_u32 v15, s72, v15
  s_lshl_b32 s72, s94, 6
  s_lshl_b32 s73, s71, 5
  s_add_u32 s72, s72, s73
  v_add_u32 v7, s72, v5
  v_mul_u32_u24 v7, 2304, v7
  v_lshl_add_u32 v7, v6, 4, v7
  s_lshl_b32 s72, s95, 7
  s_lshl_b32 s73, s70, 6
  s_add_u32 s72, s72, s73
  s_add_u32 s72, s72, 1152
  v_mov_b32 v9, 162928
  s_mov_b32 s99, 1
  s_mov_b32 s75, 64
  s_mov_b32 s77, 1431655765
  s_mov_b32 s76, 0x15
  s_branch .Lp3_l
.Lp3_z:
  s_nop 7
  s_nop 3
  v_mov_b32 v32, 0
  v_mov_b32 v33, 0
  v_mov_b32 v34, 0
  v_mov_b32 v35, 0
  v_mov_b32 v36, 0
  v_mov_b32 v37, 0
  v_mov_b32 v38, 0
  v_mov_b32 v39, 0
  v_mov_b32 v40, 0
  v_mov_b32 v41, 0
  v_mov_b32 v42, 0
  v_mov_b32 v43, 0
  v_mov_b32 v44, 0
  v_mov_b32 v45, 0
  v_mov_b32 v46, 0
  v_mov_b32 v47, 0
  s_mov_b32 s77, 0
  s_mov_b32 s99, 0
  s_mov_b32 s75, 0
  s_setprio 2
.Lp3_w:
  ds_read_b32 v10, v9
  s_waitcnt lgkmcnt(0)
  v_readfirstlane_b32 s76, v10
  s_andn2_b32 s76, s76, s77
  s_cbranch_scc0 .Lp3_w
  s_or_b32 s77, s77, s76
  s_cmp_eq_u32 s77, 1431655765
  s_cbranch_scc0 .Lp3_p
.Lp3_l:
  ds_read2st64_b32 v[232:233], v15 offset0:0 offset1:1
  ds_read2st64_b32 v[234:235], v15 offset0:2 offset1:3
  ds_read2st64_b32 v[236:237], v15 offset0:8 offset1:9
  ds_read2st64_b32 v[238:239], v15 offset0:10 offset1:11
  ds_read2st64_b32 v[240:241], v15 offset0:16 offset1:17
  ds_read2st64_b32 v[242:243], v15 offset0:18 offset1:19
  ds_read2st64_b32 v[244:245], v15 offset0:24 offset1:25
  ds_read2st64_b32 v[246:247], v15 offset0:26 offset1:27
.Lp3_p:
  s_ff1_i32_b32 s80, s76
  s_bitset0_b32 s76, s80
  v_lshl_add_u32 v17, s80, 11, v4
  ds_read_b128 v[208:211], v17
  ds_read_b128 v[212:215], v17 offset:2048
  s_lshl_b32 s80, s80, 2
  s_ff1_i32_b32 s81, s76
  s_bitset0_b32 s76, s81
  v_lshl_add_u32 v18, s81, 11, v4
  ds_read_b128 v[216:219], v18
  ds_read_b128 v[220:223], v18 offset:2048
  s_lshl_b32 s81, s81, 2
  s_ff1_i32_b32 s70, s76
  s_cmp_eq_u32 s77, 1431655765
  s_bitset0_b32 s76, s70
  v_lshl_add_u32 v16, s70, 11, v4
  s_cbranch_scc0 .Lp3_q
  s_waitcnt lgkmcnt(10)
  v_mfma_f32_32x32x16_bf16 v[32:47], v[192:195], v[232:235], v[32:47]
  s_waitcnt lgkmcnt(8)
  v_mfma_f32_32x32x16_bf16 v[32:47], v[196:199], v[236:239], v[32:47]
  s_waitcnt lgkmcnt(6)
  v_mfma_f32_32x32x16_bf16 v[32:47], v[200:203], v[240:243], v[32:47]
  s_waitcnt lgkmcnt(4)
  v_mfma_f32_32x32x16_bf16 v[32:47], v[204:207], v[244:247], v[32:47]
.Lp3_q:
  s_lshl_b32 s82, s70, 2
  s_set_gpr_idx_on s80, gpr_idx(SRC0)
  s_waitcnt lgkmcnt(2)
.Lp3_s:
  v_mfma_f32_32x32x16_bf16 v[32:47], v[64:67], v[208:211], v[32:47]
  ds_read_b128 v[224:227], v16
  ds_read_b128 v[228:231], v16 offset:2048
  s_ff1_i32_b32 s70, s76
  s_cmp_lt_i32 s81, 0
  v_mfma_f32_32x32x16_bf16 v[32:47], v[68:71], v[212:215], v[32:47]
  s_bitset0_b32 s76, s70
  v_lshl_add_u32 v16, s70, 11, v4
  s_cbranch_scc1 .Lp3_x
  s_lshl_b32 s80, s70, 2
  s_set_gpr_idx_on s81, gpr_idx(SRC0)
  s_waitcnt lgkmcnt(2)
  v_mfma_f32_32x32x16_bf16 v[32:47], v[64:67], v[216:219], v[32:47]
  ds_read_b128 v[208:211], v16
  ds_read_b128 v[212:215], v16 offset:2048
  s_ff1_i32_b32 s70, s76
  s_cmp_lt_i32 s82, 0
  v_mfma_f32_32x32x16_bf16 v[32:47], v[68:71], v[220:223], v[32:47]
  s_bitset0_b32 s76, s70
  v_lshl_add_u32 v16, s70, 11, v4
  s_cbranch_scc1 .Lp3_x
  s_lshl_b32 s81, s70, 2
  s_set_gpr_idx_on s82, gpr_idx(SRC0)
  s_waitcnt lgkmcnt(2)
  v_mfma_f32_32x32x16_bf16 v[32:47], v[64:67], v[224:227], v[32:47]
  ds_read_b128 v[216:219], v16
  ds_read_b128 v[220:223], v16 offset:2048
  s_ff1_i32_b32 s70, s76
  s_cmp_lt_i32 s80, 0
  v_mfma_f32_32x32x16_bf16 v[32:47], v[68:71], v[228:231], v[32:47]
  s_bitset0_b32 s76, s70
  v_lshl_add_u32 v16, s70, 11, v4
  s_cbranch_scc1 .Lp3_x
  s_lshl_b32 s82, s70, 2
  s_set_gpr_idx_on s80, gpr_idx(SRC0)
  s_waitcnt lgkmcnt(2)
  s_branch .Lp3_s
.Lp3_x:
  s_set_gpr_idx_off
  s_cmp_eq_u32 s77, 1431655765
  s_cbranch_scc0 .Lp3_w
.Lp3_e:
  s_nop 7
  s_nop 3
  v_cmp_u_f32 vcc, v32, v32
  s_cbranch_vccnz .Lrg_43
.Lrg_40:
  s_cmp_lg_u32 s99, 0
  v_cvt_pk_bf16_f32 v48, v32, v33
  v_cvt_pk_bf16_f32 v49, v34, v35
  v_cvt_pk_bf16_f32 v50, v36, v37
  v_cvt_pk_bf16_f32 v51, v38, v39
  v_cvt_pk_bf16_f32 v52, v40, v41
  v_cvt_pk_bf16_f32 v53, v42, v43
  v_cvt_pk_bf16_f32 v54, v44, v45
  v_cvt_pk_bf16_f32 v55, v46, v47
  s_cbranch_scc1 .Lp3_z
  buffer_store_dwordx4 v[48:51], v7, s[64:67], s72 offen
  buffer_store_dwordx4 v[52:55], v7, s[64:67], s72 offen offset:32
  s_branch .Lend
.Lp3_m:
  s_waitcnt lgkmcnt(0)
  ds_read_b128 v[208:211], v4 offset:0
  ds_read_b128 v[212:215], v4 offset:2048
  ds_read_b128 v[216:219], v4 offset:4096
  ds_read_b128 v[220:223], v4 offset:6144
  ds_read_b128 v[224:227], v4 offset:8192
  ds_read_b128 v[228:231], v4 offset:10240
  ds_read_b128 v[232:235], v4 offset:12288
  ds_read_b128 v[236:239], v4 offset:14336
  s_waitcnt lgkmcnt(7)
  v_mfma_f32_32x32x16_bf16 v[32:47], v[64:67], v[208:211], 0
  ds_read_b128 v[240:243], v4 offset:16384
  s_waitcnt lgkmcnt(7)
  v_mfma_f32_32x32x16_bf16 v[32:47], v[68:71], v[212:215], v[32:47]
  ds_read_b128 v[244:247], v4 offset:18432
  s_waitcnt lgkmcnt(7)
  v_mfma_f32_32x32x16_bf16 v[32:47], v[72:75], v[216:219], v[32:47]
  ds_read_b128 v[208:211], v4 offset:20480
  s_waitcnt lgkmcnt(7)
  v_mfma_f32_32x32x16_bf16 v[32:47], v[76:79], v[220:223], v[32:47]
  ds_read_b128 v[212:215], v4 offset:22528
  s_waitcnt lgkmcnt(7)
  v_mfma_f32_32x32x16_bf16 v[32:47], v[80:83], v[224:227], v[32:47]
  ds_read_b128 v[216:219], v4 offset:24576
  s_waitcnt lgkmcnt(7)
  v_mfma_f32_32x32x16_bf16 v[32:47], v[84:87], v[228:231], v[32:47]
  ds_read_b128 v[220:223], v4 offset:26624
  s_waitcnt lgkmcnt(7)
  v_mfma_f32_32x32x16_bf16 v[32:47], v[88:91], v[232:235], v[32:47]
  ds_read_b128 v[224:227], v4 offset:28672
  s_waitcnt lgkmcnt(7)
  v_mfma_f32_32x32x16_bf16 v[32:47], v[92:95], v[236:239], v[32:47]
  ds_read_b128 v[228:231], v4 offset:30720
  s_waitcnt lgkmcnt(7)
  v_mfma_f32_32x32x16_bf16 v[32:47], v[96:99], v[240:243], v[32:47]
  ds_read_b128 v[232:235], v4 offset:32768
  s_waitcnt lgkmcnt(7)
  v_mfma_f32_32x32x16_bf16 v[32:47], v[100:103], v[244:247], v[32:47]
  ds_read_b128 v[236:239], v4 offset:34816
  s_waitcnt lgkmcnt(7)
  v_mfma_f32_32x32x16_bf16 v[32:47], v[104:107], v[208:211], v[32:47]
  ds_read_b128 v[240:243], v4 offset:36864
  s_waitcnt lgkmcnt(7)
  v_mfma_f32_32x32x16_bf16 v[32:47], v[108:111], v[212:215], v[32:47]
  ds_read_b128 v[244:247], v4 offset:38912
  s_waitcnt lgkmcnt(7)
  v_mfma_f32_32x32x16_bf16 v[32:47], v[112:115], v[216:219], v[32:47]
  ds_read_b128 v[208:211], v4 offset:40960
  s_waitcnt lgkmcnt(7)
  v_mfma_f32_32x32x16_bf16 v[32:47], v[116:119], v[220:223], v[32:47]
  ds_read_b128 v[212:215], v4 offset:43008
  s_waitcnt lgkmcnt(7)
  v_mfma_f32_32x32x16_bf16 v[32:47], v[120:123], v[224:227], v[32:47]
  ds_read_b128 v[216:219], v4 offset:45056
  s_waitcnt lgkmcnt(7)
  v_mfma_f32_32x32x16_bf16 v[32:47], v[124:127], v[228:231], v[32:47]
  ds_read_b128 v[220:223], v4 offset:47104
  s_waitcnt lgkmcnt(7)
  v_mfma_f32_32x32x16_bf16 v[32:47], v[128:131], v[232:235], v[32:47]
  ds_read_b128 v[224:227], v4 offset:49152
  s_waitcnt lgkmcnt(7)
  v_mfma_f32_32x32x16_bf16 v[32:47], v[132:135], v[236:239], v[32:47]
  ds_read_b128 v[228:231], v4 offset:51200
  s_waitcnt lgkmcnt(7)
  v_mfma_f32_32x32x16_bf16 v[32:47], v[136:139], v[240:243], v[32:47]
  ds_read_b128 v[232:235], v4 offset:53248
  s_waitcnt lgkmcnt(7)
  v_mfma_f32_32x32x16_bf16 v[32:47], v[140:143], v[244:247], v[32:47]
  ds_read_b128 v[236:239], v4 offset:55296
  s_waitcnt lgkmcnt(7)
  v_mfma_f32_32x32x16_bf16 v[32:47], v[144:147], v[208:211], v[32:47]
  ds_read_b128 v[240:243], v4 offset:57344
  s_waitcnt lgkmcnt(7)
  v_mfma_f32_32x32x16_bf16 v[32:47], v[148:151], v[212:215], v[32:47]
  ds_read_b128 v[244:247], v4 offset:59392
  s_waitcnt lgkmcnt(7)
  v_mfma_f32_32x32x16_bf16 v[32:47], v[152:155], v[216:219], v[32:47]
  ds_read_b128 v[208:211], v4 offset:61440
  s_waitcnt lgkmcnt(7)
  v_mfma_f32_32x32x16_bf16 v[32:47], v[156:159], v[220:223], v[32:47]
  ds_read_b128 v[212:215], v4 offset:63488
  s_waitcnt lgkmcnt(7)
  v_mfma_f32_32x32x16_bf16 v[32:47], v[160:163], v[224:227], v[32:47]
  ds_read2st64_b32 v[216:217], v15 offset0:0 offset1:1
  ds_read2st64_b32 v[218:219], v15 offset0:2 offset1:3
  s_waitcnt lgkmcnt(8)
  v_mfma_f32_32x32x16_bf16 v[32:47], v[164:167], v[228:231], v[32:47]
  ds_read2st64_b32 v[220:221], v15 offset0:8 offset1:9
  ds_read2st64_b32 v[222:223], v15 offset0:10 offset1:11
  s_waitcnt lgkmcnt(9)
  v_mfma_f32_32x32x16_bf16 v[32:47], v[168:171], v[232:235], v[32:47]
  ds_read2st64_b32 v[224:225], v15 offset0:16 offset1:17
  ds_read2st64_b32 v[226:227], v15 offset0:18 offset1:19
  s_waitcnt lgkmcnt(10)
  v_mfma_f32_32x32x16_bf16 v[32:47], v[172:175], v[236:239], v[32:47]
  ds_read2st64_b32 v[228:229], v15 offset0:24 offset1:25
  ds_read2st64_b32 v[230:231], v15 offset0:26 offset1:27
  s_waitcnt lgkmcnt(11)
  v_mfma_f32_32x32x16_bf16 v[32:47], v[176:179], v[240:243], v[32:47]
  s_waitcnt lgkmcnt(10)
  v_mfma_f32_32x32x16_bf16 v[32:47], v[180:183], v[244:247], v[32:47]
  s_waitcnt lgkmcnt(9)
  v_mfma_f32_32x32x16_bf16 v[32:47], v[184:187], v[208:211], v[32:47]
  s_waitcnt lgkmcnt(8)
  v_mfma_f32_32x32x16_bf16 v[32:47], v[188:191], v[212:215], v[32:47]
  s_waitcnt lgkmcnt(6)
  v_mfma_f32_32x32x16_bf16 v[32:47], v[192:195], v[216:219], v[32:47]
  s_waitcnt lgkmcnt(4)
  v_mfma_f32_32x32x16_bf16 v[32:47], v[196:199], v[220:223], v[32:47]
  s_waitcnt lgkmcnt(2)
  v_mfma_f32_32x32x16_bf16 v[32:47], v[200:203], v[224:227], v[32:47]
  s_waitcnt lgkmcnt(0)
  v_mfma_f32_32x32x16_bf16 v[32:47], v[204:207], v[228:231], v[32:47]
  s_branch .Lp3_e
.Lat_redo:
  s_mov_b32 s98, 1
  s_waitcnt vmcnt(0) lgkmcnt(0)
  s_barrier
  v_lshlrev_b32 v4, 2, v0
  v_add_u32 v4, 162848, v4
  v_cmp_gt_u32 vcc, 3, v0
  v_mov_b32 v5, 0
  v_mov_b32 v6, 4
  v_cndmask_b32 v5, v5, v6, vcc
  s_mov_b64 exec, 0xffff
  ds_write_b32 v4, v5
  s_mov_b64 exec, -1
  v_lshlrev_b32 v4, 3, v0
  v_add_u32 v4, 162304, v4
  v_mov_b32 v6, 0
  v_mov_b32 v7, 0
  ds_write_b64 v4, v[6:7]
  s_mul_i32 s73, s94, 9
  s_add_u32 s71, s73, s97
  s_mul_i32 s71, s71, 8448
  s_add_u32 s73, s73, 8
  s_mul_i32 s73, s73, 8448
  s_lshl_b32 s74, s97, 10
  s_mul_i32 s75, s97, 1056
  s_cmp_lg_u32 s96, 0
  s_cbranch_scc1 .Lat_redo1
  s_add_u32 m0, s74, 0
  s_add_u32 s77, s71, 2433024
  buffer_load_dwordx4 v250, s[4:7], s77 offen sc1 lds
  s_add_u32 m0, s74, 4096
  s_add_u32 s77, s71, 2466816
  buffer_load_dwordx4 v250, s[4:7], s77 offen sc1 lds
  s_add_u32 m0, s75, 9216
  s_add_u32 s77, s71, 4866048
  buffer_load_dwordx4 v252, s[4:7], s77 offen sc1 lds
  s_add_u32 m0, s75, 13440
  s_add_u32 s77, s71, 4899840
  buffer_load_dwordx4 v252, s[4:7], s77 offen sc1 lds
  s_add_u32 m0, s74, 18720
  s_add_u32 s77, s71, 2434048
  buffer_load_dwordx4 v250, s[4:7], s77 offen sc1 lds
  s_add_u32 m0, s74, 22816
  s_add_u32 s77, s71, 2467840
  buffer_load_dwordx4 v250, s[4:7], s77 offen sc1 lds
  s_add_u32 m0, s75, 27936
  s_add_u32 s77, s71, 4867072
  buffer_load_dwordx4 v252, s[4:7], s77 offen sc1 lds
  s_add_u32 m0, s75, 32160
  s_add_u32 s77, s71, 4900864
  buffer_load_dwordx4 v252, s[4:7], s77 offen sc1 lds
  s_add_u32 m0, s74, 74880
  s_add_u32 s77, s71, 2435072
  buffer_load_dwordx4 v250, s[4:7], s77 offen sc1 lds
  s_add_u32 m0, s74, 78976
  s_add_u32 s77, s71, 2468864
  buffer_load_dwordx4 v250, s[4:7], s77 offen sc1 lds
  s_add_u32 m0, s75, 84096
  s_add_u32 s77, s71, 4868096
  buffer_load_dwordx4 v252, s[4:7], s77 offen sc1 lds
  s_add_u32 m0, s75, 88320
  s_add_u32 s77, s71, 4901888
  buffer_load_dwordx4 v252, s[4:7], s77 offen sc1 lds
  s_add_u32 m0, s74, 112320
  s_add_u32 s77, s71, 2436096
  buffer_load_dwordx4 v250, s[4:7], s77 offen sc1 lds
  s_add_u32 m0, s74, 116416
  s_add_u32 s77, s71, 2469888
  buffer_load_dwordx4 v250, s[4:7], s77 offen sc1 lds
  s_add_u32 m0, s75, 121536
  s_add_u32 s77, s71, 4869120
  buffer_load_dwordx4 v252, s[4:7], s77 offen sc1 lds
  s_add_u32 m0, s75, 125760
  s_add_u32 s77, s71, 4902912
  buffer_load_dwordx4 v252, s[4:7], s77 offen sc1 lds
  s_cmp_lg_u32 s97, 0
  s_cbranch_scc1 .Lr8_45
  s_mov_b32 m0, 8192
  s_add_u32 s77, s73, 2433024
  buffer_load_dwordx4 v251, s[4:7], s77 offen sc1 lds
  s_branch .Lr8_44
.Lr8_45:
  s_cmp_lg_u32 s97, 1
  s_cbranch_scc1 .Lr8_46
  s_mov_b32 m0, 17664
  s_add_u32 s77, s73, 4866048
  buffer_load_dwordx4 v252, s[4:7], s77 offen sc1 lds
  s_branch .Lr8_44
.Lr8_46:
  s_cmp_lg_u32 s97, 2
  s_cbranch_scc1 .Lr8_47
  s_mov_b32 m0, 26912
  s_add_u32 s77, s73, 2434048
  buffer_load_dwordx4 v251, s[4:7], s77 offen sc1 lds
  s_branch .Lr8_44
.Lr8_47:
  s_mov_b32 m0, 36384
  s_add_u32 s77, s73, 4867072
  buffer_load_dwordx4 v252, s[4:7], s77 offen sc1 lds
.Lr8_44:
  s_cmp_lg_u32 s97, 0
  s_cbranch_scc1 .Lr8_50
  s_mov_b32 m0, 83072
  s_add_u32 s77, s73, 2435072
  buffer_load_dwordx4 v251, s[4:7], s77 offen sc1 lds
  s_branch .Lr8_49
.Lr8_50:
  s_cmp_lg_u32 s97, 1
  s_cbranch_scc1 .Lr8_51
  s_mov_b32 m0, 92544
  s_add_u32 s77, s73, 4868096
  buffer_load_dwordx4 v252, s[4:7], s77 offen sc1 lds
  s_branch .Lr8_49
.Lr8_51:
  s_cmp_lg_u32 s97, 2
  s_cbranch_scc1 .Lr8_52
  s_mov_b32 m0, 120512
  s_add_u32 s77, s73, 2436096
  buffer_load_dwordx4 v251, s[4:7], s77 offen sc1 lds
  s_branch .Lr8_49
.Lr8_52:
  s_mov_b32 m0, 129984
  s_add_u32 s77, s73, 4869120
  buffer_load_dwordx4 v252, s[4:7], s77 offen sc1 lds
.Lr8_49:
  s_add_u32 m0, s74, 149760
  s_mov_b32 s77, s71
  s_lshl_b32 s79, s95, 10
  s_add_u32 s77, s77, s79
  buffer_load_dwordx4 v250, s[4:7], s77 offen sc1 lds
  s_add_u32 m0, s74, 153856
  s_add_u32 s77, s71, 33792
  s_lshl_b32 s79, s95, 10
  s_add_u32 s77, s77, s79
  buffer_load_dwordx4 v250, s[4:7], s77 offen sc1 lds
  s_cmp_lg_u32 s97, 0
  s_cbranch_scc1 .Lr8_55
  s_mov_b32 m0, 157952
  s_lshl_b32 s77, s95, 10
  s_add_u32 s77, s77, s73
  buffer_load_dwordx4 v251, s[4:7], s77 offen sc1 lds
  s_branch .Lr8_54
.Lr8_55:
  s_cmp_lg_u32 s97, 1
  s_cbranch_scc1 .Lr8_56
  s_mov_b32 m0, 157952
  s_lshl_b32 s77, s95, 10
  s_add_u32 s77, s77, s73
  buffer_load_dwordx4 v251, s[4:7], s77 offen sc1 lds
  s_branch .Lr8_54
.Lr8_56:
  s_cmp_lg_u32 s97, 2
  s_cbranch_scc1 .Lr8_57
  s_mov_b32 m0, 157952
  s_lshl_b32 s77, s95, 10
  s_add_u32 s77, s77, s73
  buffer_load_dwordx4 v251, s[4:7], s77 offen sc1 lds
  s_branch .Lr8_54
.Lr8_57:
  s_mov_b32 m0, 157952
  s_lshl_b32 s77, s95, 10
  s_add_u32 s77, s77, s73
  buffer_load_dwordx4 v251, s[4:7], s77 offen sc1 lds
.Lr8_54:
  s_branch .Lat_restart
.Lat_redo1:
  s_add_u32 m0, s74, 37440
  s_add_u32 s77, s71, 2437120
  buffer_load_dwordx4 v250, s[4:7], s77 offen sc1 lds
  s_add_u32 m0, s74, 41536
  s_add_u32 s77, s71, 2470912
  buffer_load_dwordx4 v250, s[4:7], s77 offen sc1 lds
  s_add_u32 m0, s75, 46656
  s_add_u32 s77, s71, 4870144
  buffer_load_dwordx4 v252, s[4:7], s77 offen sc1 lds
  s_add_u32 m0, s75, 50880
  s_add_u32 s77, s71, 4903936
  buffer_load_dwordx4 v252, s[4:7], s77 offen sc1 lds
  s_add_u32 m0, s74, 56160
  s_add_u32 s77, s71, 2438144
  buffer_load_dwordx4 v250, s[4:7], s77 offen sc1 lds
  s_add_u32 m0, s74, 60256
  s_add_u32 s77, s71, 2471936
  buffer_load_dwordx4 v250, s[4:7], s77 offen sc1 lds
  s_add_u32 m0, s75, 65376
  s_add_u32 s77, s71, 4871168
  buffer_load_dwordx4 v252, s[4:7], s77 offen sc1 lds
  s_add_u32 m0, s75, 69600
  s_add_u32 s77, s71, 4904960
  buffer_load_dwordx4 v252, s[4:7], s77 offen sc1 lds
  s_add_u32 m0, s74, 93600
  s_add_u32 s77, s71, 2439168
  buffer_load_dwordx4 v250, s[4:7], s77 offen sc1 lds
  s_add_u32 m0, s74, 97696
  s_add_u32 s77, s71, 2472960
  buffer_load_dwordx4 v250, s[4:7], s77 offen sc1 lds
  s_add_u32 m0, s75, 102816
  s_add_u32 s77, s71, 4872192
  buffer_load_dwordx4 v252, s[4:7], s77 offen sc1 lds
  s_add_u32 m0, s75, 107040
  s_add_u32 s77, s71, 4905984
  buffer_load_dwordx4 v252, s[4:7], s77 offen sc1 lds
  s_add_u32 m0, s74, 131040
  s_add_u32 s77, s71, 2440192
  buffer_load_dwordx4 v250, s[4:7], s77 offen sc1 lds
  s_add_u32 m0, s74, 135136
  s_add_u32 s77, s71, 2473984
  buffer_load_dwordx4 v250, s[4:7], s77 offen sc1 lds
  s_add_u32 m0, s75, 140256
  s_add_u32 s77, s71, 4873216
  buffer_load_dwordx4 v252, s[4:7], s77 offen sc1 lds
  s_add_u32 m0, s75, 144480
  s_add_u32 s77, s71, 4907008
  buffer_load_dwordx4 v252, s[4:7], s77 offen sc1 lds
  s_cmp_lg_u32 s97, 0
  s_cbranch_scc1 .Lr8_60
  s_mov_b32 m0, 45632
  s_add_u32 s77, s73, 2437120
  buffer_load_dwordx4 v251, s[4:7], s77 offen sc1 lds
  s_branch .Lr8_59
.Lr8_60:
  s_cmp_lg_u32 s97, 1
  s_cbranch_scc1 .Lr8_61
  s_mov_b32 m0, 55104
  s_add_u32 s77, s73, 4870144
  buffer_load_dwordx4 v252, s[4:7], s77 offen sc1 lds
  s_branch .Lr8_59
.Lr8_61:
  s_cmp_lg_u32 s97, 2
  s_cbranch_scc1 .Lr8_62
  s_mov_b32 m0, 64352
  s_add_u32 s77, s73, 2438144
  buffer_load_dwordx4 v251, s[4:7], s77 offen sc1 lds
  s_branch .Lr8_59
.Lr8_62:
  s_mov_b32 m0, 73824
  s_add_u32 s77, s73, 4871168
  buffer_load_dwordx4 v252, s[4:7], s77 offen sc1 lds
.Lr8_59:
  s_cmp_lg_u32 s97, 0
  s_cbranch_scc1 .Lr8_65
  s_mov_b32 m0, 101792
  s_add_u32 s77, s73, 2439168
  buffer_load_dwordx4 v251, s[4:7], s77 offen sc1 lds
  s_branch .Lr8_64
.Lr8_65:
  s_cmp_lg_u32 s97, 1
  s_cbranch_scc1 .Lr8_66
  s_mov_b32 m0, 111264
  s_add_u32 s77, s73, 4872192
  buffer_load_dwordx4 v252, s[4:7], s77 offen sc1 lds
  s_branch .Lr8_64
.Lr8_66:
  s_cmp_lg_u32 s97, 2
  s_cbranch_scc1 .Lr8_67
  s_mov_b32 m0, 139232
  s_add_u32 s77, s73, 2440192
  buffer_load_dwordx4 v251, s[4:7], s77 offen sc1 lds
  s_branch .Lr8_64
.Lr8_67:
  s_mov_b32 m0, 148704
  s_add_u32 s77, s73, 4873216
  buffer_load_dwordx4 v252, s[4:7], s77 offen sc1 lds
.Lr8_64:
  s_branch .Lat_restart
.Lat_truemax:
  s_waitcnt vmcnt(0) lgkmcnt(0)
  s_barrier
  ds_read_b64_tr_b16 v[192:193], v15
  ds_read_b64_tr_b16 v[194:195], v15 offset:2048
  ds_read_b64_tr_b16 v[196:197], v16
  ds_read_b64_tr_b16 v[198:199], v16 offset:2048
  ds_read_b64_tr_b16 v[200:201], v17
  s_waitcnt lgkmcnt(0)
  v_mov_b32 v201, 0
  v_mov_b32 v20, 0xff800000
  v_mov_b32 v21, 0xff800000
  s_mov_b32 s99, 0
  v_mov_b32 v5, v13
  v_xor_b32 v6, 128, v13
  v_mov_b32 v7, v14
.Lat_tm_loop:
  ds_read_b64_tr_b16 v[176:177], v5
  ds_read_b64_tr_b16 v[178:179], v5 offset:2048
  ds_read_b64_tr_b16 v[180:181], v7
  s_waitcnt lgkmcnt(0)
  v_mfma_f32_32x32x16_bf16 v[32:47], v[176:179], v[192:195], 0
  v_mfma_f32_32x32x16_bf16 v[48:63], v[176:179], v[196:199], 0
  s_nop 7
  s_nop 1
  v_mfma_f32_32x32x4_2b_bf16 v[32:63], v[180:181], v[200:201], v[32:63] cbsz:1 abid:0
  s_nop 7
  s_nop 7
  s_nop 3
  v_max3_f32 v20, v20, v32, v33
  v_max3_f32 v20, v20, v34, v35
  v_max3_f32 v20, v20, v36, v37
  v_max3_f32 v20, v20, v38, v39
  v_max3_f32 v20, v20, v40, v41
  v_max3_f32 v20, v20, v42, v43
  v_max3_f32 v20, v20, v44, v45
  v_max3_f32 v20, v20, v46, v47
  v_max3_f32 v21, v21, v48, v49
  v_max3_f32 v21, v21, v50, v51
  v_max3_f32 v21, v21, v52, v53
  v_max3_f32 v21, v21, v54, v55
  v_max3_f32 v21, v21, v56, v57
  v_max3_f32 v21, v21, v58, v59
  v_max3_f32 v21, v21, v60, v61
  v_max3_f32 v21, v21, v62, v63
  ds_read_b64_tr_b16 v[176:177], v6
  ds_read_b64_tr_b16 v[178:179], v6 offset:2048
  ds_read_b64_tr_b16 v[180:181], v7
  s_waitcnt lgkmcnt(0)
  v_mfma_f32_32x32x16_bf16 v[32:47], v[176:179], v[192:195], 0
  v_mfma_f32_32x32x16_bf16 v[48:63], v[176:179], v[196:199], 0
  s_nop 7
  s_nop 1
  v_mfma_f32_32x32x4_2b_bf16 v[32:63], v[180:181], v[200:201], v[32:63] cbsz:1 abid:1
  s_nop 7
  s_nop 7
  s_nop 3
  v_max3_f32 v20, v20, v32, v33
  v_max3_f32 v20, v20, v34, v35
  v_max3_f32 v20, v20, v36, v37
  v_max3_f32 v20, v20, v38, v39
  v_max3_f32 v20, v20, v40, v41
  v_max3_f32 v20, v20, v42, v43
  v_max3_f32 v20, v20, v44, v45
  v_max3_f32 v20, v20, v46, v47
  v_max3_f32 v21, v21, v48, v49
  v_max3_f32 v21, v21, v50, v51
  v_max3_f32 v21, v21, v52, v53
  v_max3_f32 v21, v21, v54, v55
  v_max3_f32 v21, v21, v56, v57
  v_max3_f32 v21, v21, v58, v59
  v_max3_f32 v21, v21, v60, v61
  v_max3_f32 v21, v21, v62, v63
  s_add_u32 s99, s99, 1
  s_mov_b32 s80, 17696
  s_and_b32 s79, s99, 3
  s_cselect_b32 s79, 0, s80
  s_add_u32 s79, s79, 256
  v_add_u32 v5, s79, v5
  v_add_u32 v6, s79, v6
  v_add_u32 v7, s79, v7
  s_cmp_lt_u32 s99, 32
  s_cbranch_scc1 .Lat_tm_loop
  ds_read_b64_tr_b16 v[176:177], v204
  ds_read_b64_tr_b16 v[178:179], v204 offset:2048
  ds_read_b64_tr_b16 v[180:181], v206
  v_permlane32_swap_b32 v20, v21
  s_nop 1
  v_max_f32 v20, v20, v21
  v_sub_f32 v20, 0, v20
  v_and_b32 v21, 0xffff0000, v20
  v_sub_f32 v20, v20, v21
  v_cvt_pk_bf16_f32 v201, v21, v20
  s_branch .Lat_qk
.Lat_evp2:
  s_setprio 0
  s_branch .Lat_bkp2
.Lat_evp3:
  s_setprio 0
  s_branch .Lat_bkp3
.Lat_evp5:
  s_setprio 0
  s_branch .Lat_bkp5
.Lat_eva:
  s_cmp_lt_u32 s99, 2
  s_cbranch_scc0 .Lat_eva2
  s_mul_i32 s79, s96, 16
  s_add_u32 s79, s79, 162840
  s_waitcnt vmcnt(0)
  v_mov_b32 v10, s79
  v_mov_b32 v11, 1
  s_mov_b64 exec, 1
  ds_add_u32 v10, v11
  s_mov_b64 exec, -1
  s_branch .Lat_bka
.Lat_eva2:
  s_cmp_eq_u32 s99, 3
  s_cbranch_scc1 .Lat_eva3
  s_cmp_lg_u32 s96, 0
  s_cbranch_scc1 .Lat_eva4
  v_mov_b32 v8, 162836
.Lsp_69:
  ds_read_b32 v9, v8
  s_waitcnt lgkmcnt(0)
  v_readfirstlane_b32 s79, v9
  s_cmp_lt_u32 s79, 1
  s_cbranch_scc1 .Lsp_69
  s_mul_i32 s79, s94, 40960
  s_add_u32 s80, s79, 7340032
  buffer_load_dword v96, v162, s[4:7], s80 offen offset:0 sc1
  buffer_load_dword v97, v162, s[4:7], s80 offen offset:1280 sc1
  buffer_load_dword v98, v162, s[4:7], s80 offen offset:2560 sc1
  buffer_load_dword v99, v162, s[4:7], s80 offen offset:3840 sc1
  s_add_u32 s80, s79, 7350272
  buffer_load_dword v100, v162, s[4:7], s80 offen offset:0 sc1
  buffer_load_dword v101, v162, s[4:7], s80 offen offset:1280 sc1
  buffer_load_dword v102, v162, s[4:7], s80 offen offset:2560 sc1
  buffer_load_dword v103, v162, s[4:7], s80 offen offset:3840 sc1
  s_add_u32 s80, s79, 7360512
  buffer_load_dword v104, v162, s[4:7], s80 offen offset:0 sc1
  buffer_load_dword v105, v162, s[4:7], s80 offen offset:1280 sc1
  buffer_load_dword v106, v162, s[4:7], s80 offen offset:2560 sc1
  buffer_load_dword v107, v162, s[4:7], s80 offen offset:3840 sc1
  s_add_u32 s80, s79, 7370752
  buffer_load_dword v108, v162, s[4:7], s80 offen offset:0 sc1
  buffer_load_dword v109, v162, s[4:7], s80 offen offset:1280 sc1
  buffer_load_dword v110, v162, s[4:7], s80 offen offset:2560 sc1
  buffer_load_dword v111, v162, s[4:7], s80 offen offset:3840 sc1
  s_branch .Lat_bka
.Lat_eva4:
  s_mov_b32 s79, 0
  buffer_load_dwordx2 v[210:211], v209, s[4:7], s79 offen sc1
  s_mov_b32 s79, 5120
  buffer_load_dwordx2 v[212:213], v209, s[4:7], s79 offen sc1
  s_mov_b32 s79, 10240
  buffer_load_dwordx2 v[214:215], v209, s[4:7], s79 offen sc1
  s_mov_b32 s79, 15360
  buffer_load_dwordx2 v[216:217], v209, s[4:7], s79 offen sc1
  s_branch .Lat_bka
.Lat_eva3:
  v_and_b32 v8, 7, v0
  v_cmp_gt_u32 vcc, 4, v8
  v_lshlrev_b32 v8, 6, v8
  v_add_u32 v8, 162304, v8
  v_mov_b32 v9, 93600
  v_mov_b32 v10, 74880
  v_cndmask_b32 v9, v9, v10, vcc
.Lpw_70:
  ds_read_b32 v10, v8
  s_waitcnt lgkmcnt(0)
  v_cmp_lt_u32 vcc, v10, v9
  s_cbranch_vccnz .Lpw_70
  v_lshrrev_b32 v10, 3, v0
  v_mul_u32_u24 v10, 1152, v10
  v_and_b32 v11, 16, v0
  v_lshrrev_b32 v11, 2, v11
  v_and_b32 v9, 7, v0
  v_xor_b32 v11, v11, v9
  v_lshl_add_u32 v10, v11, 4, v10
  s_lshl_b32 s79, s97, 10
  s_mul_i32 s80, s97, 9216
  s_lshl_b32 s81, s95, 7
  s_add_u32 s80, s80, s81
  s_add_u32 m0, s79, 36864
  s_add_u32 s81, s80, 331776
  buffer_load_dwordx4 v10, s[60:63], s81 offen lds
  s_add_u32 m0, s79, 40960
  s_add_u32 s81, s80, 368640
  buffer_load_dwordx4 v10, s[60:63], s81 offen lds
  s_add_u32 m0, s79, 45056
  s_add_u32 s81, s80, 405504
  buffer_load_dwordx4 v10, s[60:63], s81 offen lds
  s_add_u32 m0, s79, 49152
  s_add_u32 s81, s80, 442368
  buffer_load_dwordx4 v10, s[60:63], s81 offen lds
  s_add_u32 m0, s79, 53248
  s_add_u32 s81, s80, 479232
  buffer_load_dwordx4 v10, s[60:63], s81 offen lds
  s_add_u32 m0, s79, 57344
  s_add_u32 s81, s80, 516096
  buffer_load_dwordx4 v10, s[60:63], s81 offen lds
  s_add_u32 m0, s79, 61440
  s_add_u32 s81, s80, 552960
  buffer_load_dwordx4 v10, s[60:63], s81 offen lds
  s_add_u32 m0, s79, 65536
  s_add_u32 s81, s80, 589824
  buffer_load_dwordx4 v10, s[60:63], s81 offen lds
  s_add_u32 m0, s79, 69632
  s_add_u32 s81, s80, 626688
  buffer_load_dwordx4 v10, s[60:63], s81 offen lds
  s_branch .Lat_bka
.Lat_evb:
  s_cmp_eq_u32 s99, 1
  s_cbranch_scc1 .Lat_evb1
  s_cmp_eq_u32 s99, 2
  s_cbranch_scc1 .Lat_evb2
  s_cmp_eq_u32 s99, 3
  s_cbranch_scc1 .Lat_evb3
  s_mul_i32 s80, s96, 16
  s_add_u32 s80, s80, 162840
  v_mov_b32 v8, s80
.Lsp_71:
  ds_read_b32 v9, v8
  s_waitcnt lgkmcnt(0)
  v_readfirstlane_b32 s79, v9
  s_cmp_lt_u32 s79, 4
  s_cbranch_scc1 .Lsp_71
  s_cmp_lg_u32 s96, s1
  s_cbranch_scc1 .Lat_evb0
  v_and_b32 v25, 31, v0
  v_lshrrev_b32 v26, 5, v0
  s_and_b32 s79, s3, 1
  s_lshl_b32 s79, s79, 10
  s_add_u32 s79, s79, s94
  v_lshlrev_b32 v25, 5, v25
  v_add_u32 v25, s79, v25
  v_lshlrev_b32 v25, 12, v25
  v_lshl_add_u32 v25, v26, 4, v25
  buffer_load_dwordx4 v[218:221], v25, s[52:55], 0 offen offset:0
  buffer_load_dwordx4 v[234:237], v25, s[56:59], 0 offen offset:0
  buffer_load_dwordx4 v[222:225], v25, s[52:55], 0 offen offset:32
  buffer_load_dwordx4 v[238:241], v25, s[56:59], 0 offen offset:32
  buffer_load_dwordx4 v[226:229], v25, s[52:55], 0 offen offset:64
  buffer_load_dwordx4 v[242:245], v25, s[56:59], 0 offen offset:64
  buffer_load_dwordx4 v[230:233], v25, s[52:55], 0 offen offset:96
  buffer_load_dwordx4 v[246:249], v25, s[56:59], 0 offen offset:96
.Lat_evb0:
  s_cmp_lg_u32 s3, 4
  s_cbranch_scc1 .Lat_bkb
  v_mov_b32 v8, 162840
.Lsp_72:
  ds_read_b32 v9, v8
  s_waitcnt lgkmcnt(0)
  v_readfirstlane_b32 s79, v9
  s_cmp_lt_u32 s79, 4
  s_cbranch_scc1 .Lsp_72
  s_lshr_b32 s79, s2, 4
  s_mul_i32 s79, s79, 1280
  s_and_b32 s80, s2, 15
  s_lshl_b32 s80, s80, 3
  s_add_u32 s79, s79, s80
  s_add_u32 s79, s79, 14303232
  v_mov_b32 v25, 0
  v_mov_b32 v26, s88
  v_mov_b32 v27, s89
  s_mov_b64 exec, 1
  buffer_store_dwordx2 v[26:27], v25, s[4:7], s79 offen sc1
  s_mov_b64 exec, -1
  s_branch .Lat_bkb
.Lat_evb1:
  v_mov_b32 v8, 162856
.Lsp_73:
  ds_read_b32 v9, v8
  s_waitcnt lgkmcnt(0)
  v_readfirstlane_b32 s79, v9
  s_cmp_lt_u32 s79, 4
  s_cbranch_scc1 .Lsp_73
  s_branch .Lat_bkb
.Lat_evb3:
  v_and_b32 v8, 7, v0
  v_cmp_gt_u32 vcc, 4, v8
  v_lshlrev_b32 v8, 6, v8
  v_add_u32 v8, 162304, v8
  v_mov_b32 v9, 112320
  v_mov_b32 v10, 112320
  v_cndmask_b32 v9, v9, v10, vcc
.Lpw_74:
  ds_read_b32 v10, v8
  s_waitcnt lgkmcnt(0)
  v_cmp_lt_u32 vcc, v10, v9
  s_cbranch_vccnz .Lpw_74
  s_mul_i32 s80, s97, 5120
  s_add_u32 s80, s80, 74880
  v_lshlrev_b32 v2, 4, v0
  v_add_u32 v20, s80, v2
  s_lshl_b32 s80, s97, 2
  s_add_u32 s80, s80, 162880
  v_mov_b32 v22, s80
  v_mov_b32 v23, 1
  v_mov_b32 v21, 162872
  s_branch .Lat_bkb
.Lat_evb2:
  s_cmp_lg_u32 s96, 0
  s_cbranch_scc1 .Lat_evb4
  s_mul_i32 s79, s94, 40960
  s_add_u32 s80, s79, 8650752
  buffer_load_dword v112, v162, s[4:7], s80 offen offset:0 sc1
  buffer_load_dword v113, v162, s[4:7], s80 offen offset:1280 sc1
  buffer_load_dword v114, v162, s[4:7], s80 offen offset:2560 sc1
  buffer_load_dword v115, v162, s[4:7], s80 offen offset:3840 sc1
  s_add_u32 s80, s79, 8660992
  buffer_load_dword v116, v162, s[4:7], s80 offen offset:0 sc1
  buffer_load_dword v117, v162, s[4:7], s80 offen offset:1280 sc1
  buffer_load_dword v118, v162, s[4:7], s80 offen offset:2560 sc1
  buffer_load_dword v119, v162, s[4:7], s80 offen offset:3840 sc1
  s_add_u32 s80, s79, 8671232
  buffer_load_dword v120, v162, s[4:7], s80 offen offset:0 sc1
  buffer_load_dword v121, v162, s[4:7], s80 offen offset:1280 sc1
  buffer_load_dword v122, v162, s[4:7], s80 offen offset:2560 sc1
  buffer_load_dword v123, v162, s[4:7], s80 offen offset:3840 sc1
  s_add_u32 s80, s79, 8681472
  buffer_load_dword v124, v162, s[4:7], s80 offen offset:0 sc1
  buffer_load_dword v125, v162, s[4:7], s80 offen offset:1280 sc1
  buffer_load_dword v126, v162, s[4:7], s80 offen offset:2560 sc1
  buffer_load_dword v127, v162, s[4:7], s80 offen offset:3840 sc1
  v_and_b32 v8, 7, v0
  v_cmp_gt_u32 vcc, 4, v8
  v_lshlrev_b32 v8, 6, v8
  v_add_u32 v8, 162304, v8
  v_mov_b32 v9, 37440
  v_mov_b32 v10, 74880
  v_cndmask_b32 v9, v9, v10, vcc
.Lpw_75:
  ds_read_b32 v10, v8
  s_waitcnt lgkmcnt(0)
  v_cmp_lt_u32 vcc, v10, v9
  s_cbranch_vccnz .Lpw_75
  v_lshrrev_b32 v10, 3, v0
  v_mul_u32_u24 v10, 1152, v10
  v_and_b32 v11, 16, v0
  v_lshrrev_b32 v11, 2, v11
  v_and_b32 v9, 7, v0
  v_xor_b32 v11, v11, v9
  v_lshl_add_u32 v10, v11, 4, v10
  s_lshl_b32 s79, s97, 10
  s_mul_i32 s80, s97, 9216
  s_lshl_b32 s81, s95, 7
  s_add_u32 s80, s80, s81
  s_add_u32 m0, s79, 0
  s_add_u32 s81, s80, 0
  buffer_load_dwordx4 v10, s[60:63], s81 offen lds
  s_add_u32 m0, s79, 4096
  s_add_u32 s81, s80, 36864
  buffer_load_dwordx4 v10, s[60:63], s81 offen lds
  s_add_u32 m0, s79, 8192
  s_add_u32 s81, s80, 73728
  buffer_load_dwordx4 v10, s[60:63], s81 offen lds
  s_add_u32 m0, s79, 12288
  s_add_u32 s81, s80, 110592
  buffer_load_dwordx4 v10, s[60:63], s81 offen lds
  s_add_u32 m0, s79, 16384
  s_add_u32 s81, s80, 147456
  buffer_load_dwordx4 v10, s[60:63], s81 offen lds
  s_add_u32 m0, s79, 20480
  s_add_u32 s81, s80, 184320
  buffer_load_dwordx4 v10, s[60:63], s81 offen lds
  s_add_u32 m0, s79, 24576
  s_add_u32 s81, s80, 221184
  buffer_load_dwordx4 v10, s[60:63], s81 offen lds
  s_add_u32 m0, s79, 28672
  s_add_u32 s81, s80, 258048
  buffer_load_dwordx4 v10, s[60:63], s81 offen lds
  s_add_u32 m0, s79, 32768
  s_add_u32 s81, s80, 294912
  buffer_load_dwordx4 v10, s[60:63], s81 offen lds
  v_mul_u32_u24 v10, 1152, v0
  s_mul_i32 s80, s97, 73728
  s_lshl_b32 s81, s95, 4
  s_add_u32 s80, s80, s81
  s_add_u32 m0, s79, 149760
  s_add_u32 s81, s80, 1024
  buffer_load_dwordx4 v10, s[60:63], s81 offen lds
  s_add_u32 m0, s79, 153856
  s_add_u32 s81, s80, 295936
  buffer_load_dwordx4 v10, s[60:63], s81 offen lds
  s_cmp_lg_u32 s97, 3
  s_cbranch_scc1 .Lwa_76
  s_mov_b32 m0, 157952
  s_add_u32 s81, s80, 369664
  buffer_load_dwordx4 v10, s[60:63], s81 offen lds
.Lwa_76:
  s_branch .Lat_bkb
.Lat_evb4:
  s_cmp_lg_u32 s3, 4
  s_cbranch_scc1 .Lat_f2w
  s_waitcnt vmcnt(0)
  v_xor_b32 v30, s88, v210
  v_xor_b32 v31, s89, v211
  v_or_b32 v30, v30, v31
  v_xor_b32 v31, s88, v212
  v_or_b32 v30, v30, v31
  v_xor_b32 v31, s89, v213
  v_or_b32 v30, v30, v31
  v_xor_b32 v31, s88, v214
  v_or_b32 v30, v30, v31
  v_xor_b32 v31, s89, v215
  v_or_b32 v30, v30, v31
  v_xor_b32 v31, s88, v216
  v_or_b32 v30, v30, v31
  v_xor_b32 v31, s89, v217
  v_or_b32 v30, v30, v31
  v_cmp_ne_u32 vcc, 0, v30
  s_cbranch_vccz .Lat_f2ok
  s_mov_b32 s83, 0
.Lpoll_77:
  s_mov_b32 s79, 0
  buffer_load_dwordx2 v[210:211], v209, s[4:7], s79 offen sc1
  s_mov_b32 s79, 5120
  buffer_load_dwordx2 v[212:213], v209, s[4:7], s79 offen sc1
  s_mov_b32 s79, 10240
  buffer_load_dwordx2 v[214:215], v209, s[4:7], s79 offen sc1
  s_mov_b32 s79, 15360
  buffer_load_dwordx2 v[216:217], v209, s[4:7], s79 offen sc1
  s_waitcnt vmcnt(0)
  v_xor_b32 v30, s88, v210
  v_xor_b32 v31, s89, v211
  v_or_b32 v30, v30, v31
  v_xor_b32 v31, s88, v212
  v_or_b32 v30, v30, v31
  v_xor_b32 v31, s89, v213
  v_or_b32 v30, v30, v31
  v_xor_b32 v31, s88, v214
  v_or_b32 v30, v30, v31
  v_xor_b32 v31, s89, v215
  v_or_b32 v30, v30, v31
  v_xor_b32 v31, s88, v216
  v_or_b32 v30, v30, v31
  v_xor_b32 v31, s89, v217
  v_or_b32 v30, v30, v31
  v_cmp_ne_u32 vcc, 0, v30
  s_cbranch_vccz .Lpolx_78
  s_add_u32 s83, s83, 1
  s_cmp_lt_u32 s83, 65536
  s_cbranch_scc1 .Lpoll_77
.Lpolx_78:
.Lat_f2ok:
  v_mov_b32 v10, 162836
  v_mov_b32 v11, 1
  ds_write_b32 v10, v11
  s_cmp_eq_u32 s1, 0
  s_cbranch_scc1 .Lat_bkb
.Lat_f2w:
  v_mov_b32 v8, 162836
.Lsp_79:
  ds_read_b32 v9, v8
  s_waitcnt lgkmcnt(0)
  v_readfirstlane_b32 s79, v9
  s_cmp_lt_u32 s79, 1
  s_cbranch_scc1 .Lsp_79
  s_mul_i32 s79, s94, 40960
  s_add_u32 s80, s79, 7340032
  buffer_load_dword v96, v162, s[4:7], s80 offen offset:0 sc1
  buffer_load_dword v97, v162, s[4:7], s80 offen offset:1280 sc1
  buffer_load_dword v98, v162, s[4:7], s80 offen offset:2560 sc1
  buffer_load_dword v99, v162, s[4:7], s80 offen offset:3840 sc1
  s_add_u32 s80, s79, 7350272
  buffer_load_dword v100, v162, s[4:7], s80 offen offset:0 sc1
  buffer_load_dword v101, v162, s[4:7], s80 offen offset:1280 sc1
  buffer_load_dword v102, v162, s[4:7], s80 offen offset:2560 sc1
  buffer_load_dword v103, v162, s[4:7], s80 offen offset:3840 sc1
  s_add_u32 s80, s79, 7360512
  buffer_load_dword v104, v162, s[4:7], s80 offen offset:0 sc1
  buffer_load_dword v105, v162, s[4:7], s80 offen offset:1280 sc1
  buffer_load_dword v106, v162, s[4:7], s80 offen offset:2560 sc1
  buffer_load_dword v107, v162, s[4:7], s80 offen offset:3840 sc1
  s_add_u32 s80, s79, 7370752
  buffer_load_dword v108, v162, s[4:7], s80 offen offset:0 sc1
  buffer_load_dword v109, v162, s[4:7], s80 offen offset:1280 sc1
  buffer_load_dword v110, v162, s[4:7], s80 offen offset:2560 sc1
  buffer_load_dword v111, v162, s[4:7], s80 offen offset:3840 sc1
  s_mul_i32 s79, s94, 40960
  s_add_u32 s80, s79, 8650752
  buffer_load_dword v112, v162, s[4:7], s80 offen offset:0 sc1
  buffer_load_dword v113, v162, s[4:7], s80 offen offset:1280 sc1
  buffer_load_dword v114, v162, s[4:7], s80 offen offset:2560 sc1
  buffer_load_dword v115, v162, s[4:7], s80 offen offset:3840 sc1
  s_add_u32 s80, s79, 8660992
  buffer_load_dword v116, v162, s[4:7], s80 offen offset:0 sc1
  buffer_load_dword v117, v162, s[4:7], s80 offen offset:1280 sc1
  buffer_load_dword v118, v162, s[4:7], s80 offen offset:2560 sc1
  buffer_load_dword v119, v162, s[4:7], s80 offen offset:3840 sc1
  s_add_u32 s80, s79, 8671232
  buffer_load_dword v120, v162, s[4:7], s80 offen offset:0 sc1
  buffer_load_dword v121, v162, s[4:7], s80 offen offset:1280 sc1
  buffer_load_dword v122, v162, s[4:7], s80 offen offset:2560 sc1
  buffer_load_dword v123, v162, s[4:7], s80 offen offset:3840 sc1
  s_add_u32 s80, s79, 8681472
  buffer_load_dword v124, v162, s[4:7], s80 offen offset:0 sc1
  buffer_load_dword v125, v162, s[4:7], s80 offen offset:1280 sc1
  buffer_load_dword v126, v162, s[4:7], s80 offen offset:2560 sc1
  buffer_load_dword v127, v162, s[4:7], s80 offen offset:3840 sc1
  s_branch .Lat_bkb
.Lp3_nar:
  v_mov_b32 v9, 162928
  s_setprio 1
  buffer_store_dwordx4 v[80:83], v161, s[64:67], 0 offen
  buffer_store_dwordx4 v[84:87], v161, s[64:67], 0 offen offset:32
.Lp3_nw:
  ds_read_b32 v10, v9
  s_waitcnt lgkmcnt(0)
  v_cmp_ne_u32 vcc, 0x55555555, v10
  s_cbranch_vccnz .Lp3_nw
.Lp3_n:
  ds_read_b128 v[164:167], v23 offset:0
  ds_read_b128 v[168:171], v23 offset:4096
  ds_read_b128 v[172:175], v23 offset:8192
  ds_read_b128 v[176:179], v23 offset:12288
  ds_read_b128 v[180:183], v23 offset:16384
  ds_read_b128 v[184:187], v23 offset:20480
  ds_read_b128 v[188:191], v23 offset:24576
  ds_read_b128 v[192:195], v23 offset:28672
  ds_read_b128 v[196:199], v23 offset:32768
  ds_read_b128 v[200:203], v23 offset:36864
  s_waitcnt lgkmcnt(9)
  v_mfma_f32_16x16x32_bf16 v[32:35], v[88:91], v[164:167], 0
  ds_read_b128 v[204:207], v23 offset:40960
  s_waitcnt lgkmcnt(9)
  v_mfma_f32_16x16x32_bf16 v[32:35], v[92:95], v[168:171], v[32:35]
  ds_read_b128 v[208:211], v23 offset:45056
  s_waitcnt lgkmcnt(9)
  v_mfma_f32_16x16x32_bf16 v[32:35], v[96:99], v[172:175], v[32:35]
  ds_read_b128 v[212:215], v23 offset:49152
  s_waitcnt lgkmcnt(9)
  v_mfma_f32_16x16x32_bf16 v[32:35], v[100:103], v[176:179], v[32:35]
  ds_read_b128 v[216:219], v23 offset:53248
  s_waitcnt lgkmcnt(9)
  v_mfma_f32_16x16x32_bf16 v[32:35], v[104:107], v[180:183], v[32:35]
  ds_read_b128 v[220:223], v23 offset:57344
  s_waitcnt lgkmcnt(9)
  v_mfma_f32_16x16x32_bf16 v[32:35], v[108:111], v[184:187], v[32:35]
  ds_read_b128 v[224:227], v23 offset:61440
  s_waitcnt lgkmcnt(9)
  v_mfma_f32_16x16x32_bf16 v[32:35], v[112:115], v[188:191], v[32:35]
  ds_read2st64_b32 v[228:229], v24 offset0:0 offset1:1
  ds_read2st64_b32 v[230:231], v24 offset0:2 offset1:3
  s_waitcnt lgkmcnt(10)
  v_mfma_f32_16x16x32_bf16 v[32:35], v[116:119], v[192:195], v[32:35]
  ds_read2st64_b32 v[232:233], v24 offset0:16 offset1:17
  ds_read2st64_b32 v[234:235], v24 offset0:18 offset1:19
  s_waitcnt lgkmcnt(11)
  v_mfma_f32_16x16x32_bf16 v[32:35], v[120:123], v[196:199], v[32:35]
  s_waitcnt lgkmcnt(10)
  v_mfma_f32_16x16x32_bf16 v[32:35], v[124:127], v[200:203], v[32:35]
  s_waitcnt lgkmcnt(9)
  v_mfma_f32_16x16x32_bf16 v[32:35], v[128:131], v[204:207], v[32:35]
  s_waitcnt lgkmcnt(8)
  v_mfma_f32_16x16x32_bf16 v[32:35], v[132:135], v[208:211], v[32:35]
  s_waitcnt lgkmcnt(7)
  v_mfma_f32_16x16x32_bf16 v[32:35], v[136:139], v[212:215], v[32:35]
  s_waitcnt lgkmcnt(6)
  v_mfma_f32_16x16x32_bf16 v[32:35], v[140:143], v[216:219], v[32:35]
  s_waitcnt lgkmcnt(5)
  v_mfma_f32_16x16x32_bf16 v[32:35], v[144:147], v[220:223], v[32:35]
  s_waitcnt lgkmcnt(4)
  v_mfma_f32_16x16x32_bf16 v[32:35], v[148:151], v[224:227], v[32:35]
  s_waitcnt lgkmcnt(2)
  v_mfma_f32_16x16x32_bf16 v[32:35], v[152:155], v[228:231], v[32:35]
  s_waitcnt lgkmcnt(0)
  v_mfma_f32_16x16x32_bf16 v[32:35], v[156:159], v[232:235], v[32:35]
  s_nop 7
  v_cmp_u_f32 vcc, v32, v32
  s_cbranch_vccnz .Lrg_83
.Lrg_80:
  v_cvt_pk_bf16_f32 v48, v32, v33
  v_cvt_pk_bf16_f32 v49, v34, v35
  s_mov_b64 exec, 0xffffffff
  buffer_store_dwordx2 v[48:49], v25, s[64:67], s72 offen
.Lend:
.Lexit:
  s_endpgm
.Lrg_43:
  s_add_u32 s75, s75, 1
  s_cmp_ge_u32 s75, 64
  s_cbranch_scc1 .Lrg_40
  v_lshlrev_b32 v2, 4, v0
  s_lshl_b32 s79, s94, 10
  s_add_u32 s79, s79, 9961472
  s_mov_b32 m0, 73728
.Lrg_41:
  s_nop 0
  buffer_load_dwordx4 v2, s[4:7], s79 offen sc1 lds
  s_add_u32 s79, s79, 32768
  s_add_u32 m0, m0, 1024
  s_cmp_lt_u32 m0, 139264
  s_cbranch_scc1 .Lrg_41
  v_lshrrev_b32 v12, 4, v0
  v_lshlrev_b32 v12, 13, v12
  v_and_b32 v13, 15, v0
  v_lshl_add_u32 v12, v13, 4, v12
  s_lshl_b32 s79, s94, 8
  s_add_u32 s79, s79, 12058624
.Lrg_42:
  s_nop 0
  buffer_load_dwordx4 v12, s[4:7], s79 offen sc1 lds
  s_add_u32 s79, s79, 32768
  s_add_u32 m0, m0, 1024
  s_cmp_lt_u32 m0, 147456
  s_cbranch_scc1 .Lrg_42
  s_waitcnt vmcnt(0)
  s_branch .Lp3_m
.Lrg_83:
  s_add_u32 s75, s75, 1
  s_cmp_ge_u32 s75, 64
  s_cbranch_scc1 .Lrg_80
  v_lshlrev_b32 v2, 4, v0
  s_lshl_b32 s79, s94, 10
  s_add_u32 s79, s79, 9961472
  s_mov_b32 m0, 73728
.Lrg_81:
  s_nop 0
  buffer_load_dwordx4 v2, s[4:7], s79 offen sc1 lds
  s_add_u32 s79, s79, 32768
  s_add_u32 m0, m0, 1024
  s_cmp_lt_u32 m0, 139264
  s_cbranch_scc1 .Lrg_81
  v_lshrrev_b32 v12, 4, v0
  v_lshlrev_b32 v12, 13, v12
  v_and_b32 v13, 15, v0
  v_lshl_add_u32 v12, v13, 4, v12
  s_lshl_b32 s79, s94, 8
  s_add_u32 s79, s79, 12058624
.Lrg_82:
  s_nop 0
  buffer_load_dwordx4 v12, s[4:7], s79 offen sc1 lds
  s_add_u32 s79, s79, 32768
  s_add_u32 m0, m0, 1024
  s_cmp_lt_u32 m0, 147456
  s_cbranch_scc1 .Lrg_82
  s_waitcnt vmcnt(0)
  s_branch .Lp3_n
.Ll_spare:
  s_mov_b32 s40, s8
  s_mov_b32 s41, s9
  s_mov_b32 s42, 2359296
  s_mov_b32 s43, 0x20000
  s_add_u32 s92, s92, 4
  s_add_u32 s80, s92, 0
  s_and_b32 s79, s80, 3
  s_lshl_b32 s81, s68, 2
  s_add_u32 s79, s79, s81
  s_lshr_b32 s80, s80, 2
  v_lshrrev_b32 v6, 3, v0
  v_lshrrev_b32 v7, 2, v6
  v_and_b32 v8, 3, v6
  v_lshl_add_u32 v8, v7, 3, v8
  s_and_b32 s81, s70, 1
  s_lshl_b32 s81, s81, 8
  s_lshr_b32 s82, s70, 1
  s_add_u32 s81, s81, s82
  s_lshl_b32 s82, s79, 1
  s_add_u32 s81, s81, s82
  v_lshlrev_b32 v8, 6, v8
  v_add_u32 v8, s81, v8
  v_mul_u32_u24 v8, 1152, v8
  v_add_u32 v40, v8, v4
  v_add_u32 v41, 1178624, v8
  v_add_u32 v41, v41, v5
  s_lshl_b32 s81, s80, 5
  s_lshl_b32 s82, s70, 3
  s_add_u32 s81, s81, s82
  v_and_b32 v8, 7, v0
  v_add_u32 v42, s81, v8
  s_lshl_b32 s81, s70, 4
  v_add_u32 v8, s81, v6
  v_mul_u32_u24 v8, 40960, v8
  v_and_b32 v7, 7, v0
  v_lshl_add_u32 v8, v7, 4, v8
  s_mul_i32 s81, s79, 1280
  s_lshl_b32 s82, s80, 7
  s_add_u32 s81, s81, s82
  s_add_u32 s81, s81, 7340032
  v_add_u32 v52, s81, v8
  s_mov_b32 s4, s28
  s_mov_b32 s5, s29
  s_mov_b32 s6, 268435456
  s_mov_b32 s7, 0x20000
  s_mov_b32 s60, s22
  s_mov_b32 s61, s23
  s_mov_b32 s62, 663552
  s_mov_b32 s63, 0x20000
  s_mov_b32 s52, s10
  s_mov_b32 s53, s11
  s_mov_b32 s54, 8388608
  s_mov_b32 s55, 0x20000
  s_mov_b32 s56, s12
  s_mov_b32 s57, s13
  s_mov_b32 s58, 8388608
  s_mov_b32 s59, 0x20000
  s_mov_b32 s64, s24
  s_mov_b32 s65, s25
  s_mov_b32 s66, 4718592
  s_mov_b32 s67, 0x20000
  s_lshl_b32 s94, s68, 2
  s_lshr_b32 s95, s69, 3
  s_add_u32 s94, s94, s95
  s_and_b32 s95, s69, 7
  s_lshr_b32 s96, s3, 2
  s_and_b32 s97, s3, 3
  s_mov_b32 s98, 0
  v_lshrrev_b32 v6, 3, v0
  v_lshlrev_b32 v6, 7, v6
  v_and_b32 v7, 2, v0
  v_lshlrev_b32 v7, 5, v7
  v_and_b32 v8, 4, v0
  v_lshl_add_u32 v7, v8, 3, v7
  v_and_b32 v8, 1, v0
  v_lshl_add_u32 v7, v8, 4, v7
  v_add_u32 v251, v6, v7
  s_and_b32 s79, s3, 1
  s_lshl_b32 s79, s79, 7
  v_xor_b32 v250, s79, v251
  v_and_b32 v7, 4, v0
  v_lshlrev_b32 v7, 4, v7
  v_and_b32 v8, 1, v0
  v_lshl_add_u32 v7, v8, 5, v7
  v_and_b32 v8, 2, v0
  v_lshl_add_u32 v7, v8, 3, v7
  v_add_u32 v252, v6, v7
  s_barrier
  s_setprio 2
  v_and_b32 v6, 15, v0
  v_lshrrev_b32 v7, 1, v6
  v_lshrrev_b32 v8, 4, v0
  v_xor_b32 v7, v7, v8
  v_lshlrev_b32 v6, 7, v6
  v_lshl_add_u32 v60, v7, 4, v6
  v_xor_b32 v61, 64, v60
  v_add_u32 v62, 131072, v60
  v_add_u32 v63, 131072, v61
  v_add_u32 v60, 40960, v60
  v_add_u32 v61, 40960, v61
  v_mov_b32 v56, 162816
  v_mov_b32 v57, 1
  v_bfe_u32 v6, v0, 3, 1
  v_mul_u32_u24 v55, 0x8000, v6
  v_lshl_or_b32 v55, v55, 16, v55
  v_lshlrev_b32 v6, 12, v6
  v_lshl_add_u32 v6, v8, 9, v6
  v_and_b32 v7, 7, v0
  v_lshl_add_u32 v6, v7, 2, v6
  s_lshl_b32 s79, s70, 5
  s_add_u32 s79, s79, 98304
  v_add_u32 v53, s79, v6
  s_add_u32 s79, s72, 98304
  v_lshlrev_b32 v6, 4, v0
  v_add_u32 v59, s79, v6
  v_and_b32 v2, 15, v0
  v_lshlrev_b32 v2, 18, v2
  v_lshrrev_b32 v3, 4, v0
  v_lshl_add_u32 v2, v3, 4, v2
  s_mov_b32 s79, 4194304
  buffer_load_dwordx4 v[16:19], v2, s[52:55], 0 offen
  buffer_load_dwordx4 v[20:23], v2, s[52:55], s79 offen
  buffer_load_dwordx4 v[24:27], v2, s[56:59], 0 offen
  buffer_load_dwordx4 v[28:31], v2, s[56:59], s79 offen
  v_cvt_f32_u32 v43, v42
  v_and_b32 v6, 1, v42
  v_lshlrev_b32 v6, 1, v6
  v_bfe_u32 v7, v0, 3, 1
  v_add_u32 v6, v6, v7
  v_cvt_f32_u32 v6, v6
  v_mul_f32 v43, 987991609, v43
  v_mul_f32 v6, 0x3e800000, v6
  v_lshrrev_b32 v7, 4, v0
  v_lshlrev_b32 v7, 3, v7
  v_subrev_u32 v7, 288, v7
  v_cvt_f32_i32 v7, v7
  v_fma_f32 v44, v7, v43, v6
  s_mov_b32 s77, s99
  v_and_b32 v6, 8, v0
  v_cmp_eq_u32 vcc, 0, v6
  v_mov_b32 v6, 0xbf803f80
  s_nop 0
  v_cndmask_b32 v232, 0, v6, vcc
  v_mov_b32 v233, v232
  v_mov_b32 v234, v232
  v_mov_b32 v235, v232
  s_lshl_b32 s76, s77, 6
  v_cvt_f32_u32 v45, s76
  s_add_u32 s77, s77, 1
  s_cmp_eq_u32 s77, 9
  s_cselect_b32 s77, 0, s77
  v_fma_f32 v45, v45, v43, v44
  v_fmamk_f32 v47, v43, 1065353216, v45
  v_fmamk_f32 v48, v43, 1073741824, v45
  v_fmamk_f32 v49, v43, 1077936128, v45
  v_fmamk_f32 v50, v43, 1082130432, v45
  v_fmamk_f32 v51, v43, 1084227584, v45
  v_fmamk_f32 v8, v43, 1086324736, v45
  v_fmamk_f32 v9, v43, 1088421888, v45
  v_cos_f32 v46, v45
  v_cos_f32 v47, v47
  v_cos_f32 v48, v48
  v_cos_f32 v49, v49
  v_cos_f32 v50, v50
  v_cos_f32 v51, v51
  v_cos_f32 v8, v8
  v_cos_f32 v9, v9
  v_cvt_pk_bf16_f32 v128, v46, v47
  v_cvt_pk_bf16_f32 v129, v48, v49
  v_cvt_pk_bf16_f32 v130, v50, v51
  v_cvt_pk_bf16_f32 v131, v8, v9
  v_fmamk_f32 v46, v43, 1107296256, v45
  v_fmamk_f32 v47, v43, 1107558400, v45
  v_fmamk_f32 v48, v43, 1107820544, v45
  v_fmamk_f32 v49, v43, 1108082688, v45
  v_fmamk_f32 v50, v43, 1108344832, v45
  v_fmamk_f32 v51, v43, 1108606976, v45
  v_fmamk_f32 v8, v43, 1108869120, v45
  v_fmamk_f32 v9, v43, 1109131264, v45
  v_cos_f32 v46, v46
  v_cos_f32 v47, v47
  v_cos_f32 v48, v48
  v_cos_f32 v49, v49
  v_cos_f32 v50, v50
  v_cos_f32 v51, v51
  v_cos_f32 v8, v8
  v_cos_f32 v9, v9
  v_cvt_pk_bf16_f32 v132, v46, v47
  v_cvt_pk_bf16_f32 v133, v48, v49
  v_cvt_pk_bf16_f32 v134, v50, v51
  v_cvt_pk_bf16_f32 v135, v8, v9
  s_lshl_b32 s73, s75, 7
  s_add_u32 m0, s72, 131072
  s_add_u32 s75, s75, 1
  buffer_load_dwordx4 v40, s[40:43], s73 offen lds
  s_cmp_eq_u32 s75, 9
  s_cselect_b32 s75, 0, s75
  buffer_load_dwordx4 v41, s[40:43], s73 offen offset:1024 lds
  s_lshl_b32 s73, s75, 7
  s_add_u32 m0, s72, 139264
  s_add_u32 s75, s75, 1
  buffer_load_dwordx4 v40, s[40:43], s73 offen lds
  s_cmp_eq_u32 s75, 9
  s_cselect_b32 s75, 0, s75
  buffer_load_dwordx4 v41, s[40:43], s73 offen offset:1024 lds
  s_lshl_b32 s76, s77, 6
  v_cvt_f32_u32 v45, s76
  s_add_u32 s77, s77, 1
  s_cmp_eq_u32 s77, 9
  s_cselect_b32 s77, 0, s77
  v_fma_f32 v45, v45, v43, v44
  v_fmamk_f32 v47, v43, 1065353216, v45
  v_fmamk_f32 v48, v43, 1073741824, v45
  v_fmamk_f32 v49, v43, 1077936128, v45
  v_fmamk_f32 v50, v43, 1082130432, v45
  v_fmamk_f32 v51, v43, 1084227584, v45
  v_fmamk_f32 v8, v43, 1086324736, v45
  v_fmamk_f32 v9, v43, 1088421888, v45
  v_cos_f32 v46, v45
  v_cos_f32 v47, v47
  v_cos_f32 v48, v48
  v_cos_f32 v49, v49
  v_cos_f32 v50, v50
  v_cos_f32 v51, v51
  v_cos_f32 v8, v8
  v_cos_f32 v9, v9
  v_cvt_pk_bf16_f32 v136, v46, v47
  v_cvt_pk_bf16_f32 v137, v48, v49
  v_cvt_pk_bf16_f32 v138, v50, v51
  v_cvt_pk_bf16_f32 v139, v8, v9
  v_fmamk_f32 v46, v43, 1107296256, v45
  v_fmamk_f32 v47, v43, 1107558400, v45
  v_fmamk_f32 v48, v43, 1107820544, v45
  v_fmamk_f32 v49, v43, 1108082688, v45
  v_fmamk_f32 v50, v43, 1108344832, v45
  v_fmamk_f32 v51, v43, 1108606976, v45
  v_fmamk_f32 v8, v43, 1108869120, v45
  v_fmamk_f32 v9, v43, 1109131264, v45
  v_cos_f32 v46, v46
  v_cos_f32 v47, v47
  v_cos_f32 v48, v48
  v_cos_f32 v49, v49
  v_cos_f32 v50, v50
  v_cos_f32 v51, v51
  v_cos_f32 v8, v8
  v_cos_f32 v9, v9
  v_cvt_pk_bf16_f32 v140, v46, v47
  v_cvt_pk_bf16_f32 v141, v48, v49
  v_cvt_pk_bf16_f32 v142, v50, v51
  v_cvt_pk_bf16_f32 v143, v8, v9
  s_lshl_b32 s73, s75, 7
  s_add_u32 m0, s72, 40960
  s_add_u32 s75, s75, 1
  buffer_load_dwordx4 v40, s[40:43], s73 offen lds
  s_cmp_eq_u32 s75, 9
  s_cselect_b32 s75, 0, s75
  buffer_load_dwordx4 v41, s[40:43], s73 offen offset:1024 lds
  s_lshl_b32 s73, s75, 7
  s_add_u32 m0, s72, 49152
  s_add_u32 s75, s75, 1
  buffer_load_dwordx4 v40, s[40:43], s73 offen lds
  s_cmp_eq_u32 s75, 9
  s_cselect_b32 s75, 0, s75
  buffer_load_dwordx4 v41, s[40:43], s73 offen offset:1024 lds
  s_lshl_b32 s76, s77, 6
  v_cvt_f32_u32 v45, s76
  s_add_u32 s77, s77, 1
  s_cmp_eq_u32 s77, 9
  s_cselect_b32 s77, 0, s77
  v_fma_f32 v45, v45, v43, v44
  v_fmamk_f32 v47, v43, 1065353216, v45
  v_fmamk_f32 v48, v43, 1073741824, v45
  v_fmamk_f32 v49, v43, 1077936128, v45
  v_fmamk_f32 v50, v43, 1082130432, v45
  v_fmamk_f32 v51, v43, 1084227584, v45
  v_fmamk_f32 v8, v43, 1086324736, v45
  v_fmamk_f32 v9, v43, 1088421888, v45
  v_cos_f32 v46, v45
  v_cos_f32 v47, v47
  v_cos_f32 v48, v48
  v_cos_f32 v49, v49
  v_cos_f32 v50, v50
  v_cos_f32 v51, v51
  v_cos_f32 v8, v8
  v_cos_f32 v9, v9
  v_cvt_pk_bf16_f32 v144, v46, v47
  v_cvt_pk_bf16_f32 v145, v48, v49
  v_cvt_pk_bf16_f32 v146, v50, v51
  v_cvt_pk_bf16_f32 v147, v8, v9
  v_fmamk_f32 v46, v43, 1107296256, v45
  v_fmamk_f32 v47, v43, 1107558400, v45
  v_fmamk_f32 v48, v43, 1107820544, v45
  v_fmamk_f32 v49, v43, 1108082688, v45
  v_fmamk_f32 v50, v43, 1108344832, v45
  v_fmamk_f32 v51, v43, 1108606976, v45
  v_fmamk_f32 v8, v43, 1108869120, v45
  v_fmamk_f32 v9, v43, 1109131264, v45
  v_cos_f32 v46, v46
  v_cos_f32 v47, v47
  v_cos_f32 v48, v48
  v_cos_f32 v49, v49
  v_cos_f32 v50, v50
  v_cos_f32 v51, v51
  v_cos_f32 v8, v8
  v_cos_f32 v9, v9
  v_cvt_pk_bf16_f32 v148, v46, v47
  v_cvt_pk_bf16_f32 v149, v48, v49
  v_cvt_pk_bf16_f32 v150, v50, v51
  v_cvt_pk_bf16_f32 v151, v8, v9
  s_lshl_b32 s73, s75, 7
  s_add_u32 m0, s72, 57344
  s_add_u32 s75, s75, 1
  buffer_load_dwordx4 v40, s[40:43], s73 offen lds
  s_cmp_eq_u32 s75, 9
  s_cselect_b32 s75, 0, s75
  buffer_load_dwordx4 v41, s[40:43], s73 offen offset:1024 lds
  s_lshl_b32 s73, s75, 7
  s_add_u32 m0, s72, 65536
  s_add_u32 s75, s75, 1
  buffer_load_dwordx4 v40, s[40:43], s73 offen lds
  s_cmp_eq_u32 s75, 9
  s_cselect_b32 s75, 0, s75
  buffer_load_dwordx4 v41, s[40:43], s73 offen offset:1024 lds
  s_lshl_b32 s76, s77, 6
  v_cvt_f32_u32 v45, s76
  s_add_u32 s77, s77, 1
  s_cmp_eq_u32 s77, 9
  s_cselect_b32 s77, 0, s77
  v_fma_f32 v45, v45, v43, v44
  v_fmamk_f32 v47, v43, 1065353216, v45
  v_fmamk_f32 v48, v43, 1073741824, v45
  v_fmamk_f32 v49, v43, 1077936128, v45
  v_fmamk_f32 v50, v43, 1082130432, v45
  v_fmamk_f32 v51, v43, 1084227584, v45
  v_fmamk_f32 v8, v43, 1086324736, v45
  v_fmamk_f32 v9, v43, 1088421888, v45
  v_cos_f32 v46, v45
  v_cos_f32 v47, v47
  v_cos_f32 v48, v48
  v_cos_f32 v49, v49
  v_cos_f32 v50, v50
  v_cos_f32 v51, v51
  v_cos_f32 v8, v8
  v_cos_f32 v9, v9
  v_cvt_pk_bf16_f32 v152, v46, v47
  v_cvt_pk_bf16_f32 v153, v48, v49
  v_cvt_pk_bf16_f32 v154, v50, v51
  v_cvt_pk_bf16_f32 v155, v8, v9
  v_fmamk_f32 v46, v43, 1107296256, v45
  v_fmamk_f32 v47, v43, 1107558400, v45
  v_fmamk_f32 v48, v43, 1107820544, v45
  v_fmamk_f32 v49, v43, 1108082688, v45
  v_fmamk_f32 v50, v43, 1108344832, v45
  v_fmamk_f32 v51, v43, 1108606976, v45
  v_fmamk_f32 v8, v43, 1108869120, v45
  v_fmamk_f32 v9, v43, 1109131264, v45
  v_cos_f32 v46, v46
  v_cos_f32 v47, v47
  v_cos_f32 v48, v48
  v_cos_f32 v49, v49
  v_cos_f32 v50, v50
  v_cos_f32 v51, v51
  v_cos_f32 v8, v8
  v_cos_f32 v9, v9
  v_cvt_pk_bf16_f32 v156, v46, v47
  v_cvt_pk_bf16_f32 v157, v48, v49
  v_cvt_pk_bf16_f32 v158, v50, v51
  v_cvt_pk_bf16_f32 v159, v8, v9
  s_lshl_b32 s73, s75, 7
  s_add_u32 m0, s72, 73728
  s_add_u32 s75, s75, 1
  buffer_load_dwordx4 v40, s[40:43], s73 offen lds
  s_cmp_eq_u32 s75, 9
  s_cselect_b32 s75, 0, s75
  buffer_load_dwordx4 v41, s[40:43], s73 offen offset:1024 lds
  s_lshl_b32 s73, s75, 7
  s_add_u32 m0, s72, 81920
  s_add_u32 s75, s75, 1
  buffer_load_dwordx4 v40, s[40:43], s73 offen lds
  s_cmp_eq_u32 s75, 9
  s_cselect_b32 s75, 0, s75
  buffer_load_dwordx4 v41, s[40:43], s73 offen offset:1024 lds
  s_lshl_b32 s76, s77, 6
  v_cvt_f32_u32 v45, s76
  s_add_u32 s77, s77, 1
  s_cmp_eq_u32 s77, 9
  s_cselect_b32 s77, 0, s77
  v_fma_f32 v45, v45, v43, v44
  v_fmamk_f32 v47, v43, 1065353216, v45
  v_fmamk_f32 v48, v43, 1073741824, v45
  v_fmamk_f32 v49, v43, 1077936128, v45
  v_fmamk_f32 v50, v43, 1082130432, v45
  v_fmamk_f32 v51, v43, 1084227584, v45
  v_fmamk_f32 v8, v43, 1086324736, v45
  v_fmamk_f32 v9, v43, 1088421888, v45
  v_cos_f32 v46, v45
  v_cos_f32 v47, v47
  v_cos_f32 v48, v48
  v_cos_f32 v49, v49
  v_cos_f32 v50, v50
  v_cos_f32 v51, v51
  v_cos_f32 v8, v8
  v_cos_f32 v9, v9
  v_cvt_pk_bf16_f32 v160, v46, v47
  v_cvt_pk_bf16_f32 v161, v48, v49
  v_cvt_pk_bf16_f32 v162, v50, v51
  v_cvt_pk_bf16_f32 v163, v8, v9
  v_fmamk_f32 v46, v43, 1107296256, v45
  v_fmamk_f32 v47, v43, 1107558400, v45
  v_fmamk_f32 v48, v43, 1107820544, v45
  v_fmamk_f32 v49, v43, 1108082688, v45
  v_fmamk_f32 v50, v43, 1108344832, v45
  v_fmamk_f32 v51, v43, 1108606976, v45
  v_fmamk_f32 v8, v43, 1108869120, v45
  v_fmamk_f32 v9, v43, 1109131264, v45
  v_cos_f32 v46, v46
  v_cos_f32 v47, v47
  v_cos_f32 v48, v48
  v_cos_f32 v49, v49
  v_cos_f32 v50, v50
  v_cos_f32 v51, v51
  v_cos_f32 v8, v8
  v_cos_f32 v9, v9
  v_cvt_pk_bf16_f32 v164, v46, v47
  v_cvt_pk_bf16_f32 v165, v48, v49
  v_cvt_pk_bf16_f32 v166, v50, v51
  v_cvt_pk_bf16_f32 v167, v8, v9
  s_lshl_b32 s73, s75, 7
  s_add_u32 m0, s72, 90112
  s_add_u32 s75, s75, 1
  buffer_load_dwordx4 v40, s[40:43], s73 offen lds
  s_cmp_eq_u32 s75, 9
  s_cselect_b32 s75, 0, s75
  buffer_load_dwordx4 v41, s[40:43], s73 offen offset:1024 lds
  s_waitcnt vmcnt(8)
  v_mov_b32 v6, 162976
  v_mov_b32 v7, 1
  s_mov_b64 exec, 1
  ds_add_u32 v6, v7
  s_mov_b64 exec, -1
  s_lshl_b32 s76, s77, 6
  v_cvt_f32_u32 v45, s76
  s_add_u32 s77, s77, 1
  s_cmp_eq_u32 s77, 9
  s_cselect_b32 s77, 0, s77
  v_fma_f32 v45, v45, v43, v44
  v_fmamk_f32 v47, v43, 1065353216, v45
  v_fmamk_f32 v48, v43, 1073741824, v45
  v_fmamk_f32 v49, v43, 1077936128, v45
  v_fmamk_f32 v50, v43, 1082130432, v45
  v_fmamk_f32 v51, v43, 1084227584, v45
  v_fmamk_f32 v8, v43, 1086324736, v45
  v_fmamk_f32 v9, v43, 1088421888, v45
  v_cos_f32 v46, v45
  v_cos_f32 v47, v47
  v_cos_f32 v48, v48
  v_cos_f32 v49, v49
  v_cos_f32 v50, v50
  v_cos_f32 v51, v51
  v_cos_f32 v8, v8
  v_cos_f32 v9, v9
  v_cvt_pk_bf16_f32 v168, v46, v47
  v_cvt_pk_bf16_f32 v169, v48, v49
  v_cvt_pk_bf16_f32 v170, v50, v51
  v_cvt_pk_bf16_f32 v171, v8, v9
  v_fmamk_f32 v46, v43, 1107296256, v45
  v_fmamk_f32 v47, v43, 1107558400, v45
  v_fmamk_f32 v48, v43, 1107820544, v45
  v_fmamk_f32 v49, v43, 1108082688, v45
  v_fmamk_f32 v50, v43, 1108344832, v45
  v_fmamk_f32 v51, v43, 1108606976, v45
  v_fmamk_f32 v8, v43, 1108869120, v45
  v_fmamk_f32 v9, v43, 1109131264, v45
  v_cos_f32 v46, v46
  v_cos_f32 v47, v47
  v_cos_f32 v48, v48
  v_cos_f32 v49, v49
  v_cos_f32 v50, v50
  v_cos_f32 v51, v51
  v_cos_f32 v8, v8
  v_cos_f32 v9, v9
  v_cvt_pk_bf16_f32 v172, v46, v47
  v_cvt_pk_bf16_f32 v173, v48, v49
  v_cvt_pk_bf16_f32 v174, v50, v51
  v_cvt_pk_bf16_f32 v175, v8, v9
  s_lshl_b32 s76, s77, 6
  v_cvt_f32_u32 v45, s76
  s_add_u32 s77, s77, 1
  s_cmp_eq_u32 s77, 9
  s_cselect_b32 s77, 0, s77
  v_fma_f32 v45, v45, v43, v44
  v_fmamk_f32 v47, v43, 1065353216, v45
  v_fmamk_f32 v48, v43, 1073741824, v45
  v_fmamk_f32 v49, v43, 1077936128, v45
  v_fmamk_f32 v50, v43, 1082130432, v45
  v_fmamk_f32 v51, v43, 1084227584, v45
  v_fmamk_f32 v8, v43, 1086324736, v45
  v_fmamk_f32 v9, v43, 1088421888, v45
  v_cos_f32 v46, v45
  v_cos_f32 v47, v47
  v_cos_f32 v48, v48
  v_cos_f32 v49, v49
  v_cos_f32 v50, v50
  v_cos_f32 v51, v51
  v_cos_f32 v8, v8
  v_cos_f32 v9, v9
  v_cvt_pk_bf16_f32 v176, v46, v47
  v_cvt_pk_bf16_f32 v177, v48, v49
  v_cvt_pk_bf16_f32 v178, v50, v51
  v_cvt_pk_bf16_f32 v179, v8, v9
  v_fmamk_f32 v46, v43, 1107296256, v45
  v_fmamk_f32 v47, v43, 1107558400, v45
  v_fmamk_f32 v48, v43, 1107820544, v45
  v_fmamk_f32 v49, v43, 1108082688, v45
  v_fmamk_f32 v50, v43, 1108344832, v45
  v_fmamk_f32 v51, v43, 1108606976, v45
  v_fmamk_f32 v8, v43, 1108869120, v45
  v_fmamk_f32 v9, v43, 1109131264, v45
  v_cos_f32 v46, v46
  v_cos_f32 v47, v47
  v_cos_f32 v48, v48
  v_cos_f32 v49, v49
  v_cos_f32 v50, v50
  v_cos_f32 v51, v51
  v_cos_f32 v8, v8
  v_cos_f32 v9, v9
  v_cvt_pk_bf16_f32 v180, v46, v47
  v_cvt_pk_bf16_f32 v181, v48, v49
  v_cvt_pk_bf16_f32 v182, v50, v51
  v_cvt_pk_bf16_f32 v183, v8, v9
  s_waitcnt vmcnt(0)
  v_mov_b32 v6, 162980
  v_mov_b32 v7, 1
  s_mov_b64 exec, 1
  ds_add_u32 v6, v7
  s_mov_b64 exec, -1
  s_lshl_b32 s76, s77, 6
  v_cvt_f32_u32 v45, s76
  s_add_u32 s77, s77, 1
  s_cmp_eq_u32 s77, 9
  s_cselect_b32 s77, 0, s77
  v_fma_f32 v45, v45, v43, v44
  v_fmamk_f32 v47, v43, 1065353216, v45
  v_fmamk_f32 v48, v43, 1073741824, v45
  v_fmamk_f32 v49, v43, 1077936128, v45
  v_fmamk_f32 v50, v43, 1082130432, v45
  v_fmamk_f32 v51, v43, 1084227584, v45
  v_fmamk_f32 v8, v43, 1086324736, v45
  v_fmamk_f32 v9, v43, 1088421888, v45
  v_cos_f32 v46, v45
  v_cos_f32 v47, v47
  v_cos_f32 v48, v48
  v_cos_f32 v49, v49
  v_cos_f32 v50, v50
  v_cos_f32 v51, v51
  v_cos_f32 v8, v8
  v_cos_f32 v9, v9
  v_cvt_pk_bf16_f32 v184, v46, v47
  v_cvt_pk_bf16_f32 v185, v48, v49
  v_cvt_pk_bf16_f32 v186, v50, v51
  v_cvt_pk_bf16_f32 v187, v8, v9
  v_fmamk_f32 v46, v43, 1107296256, v45
  v_fmamk_f32 v47, v43, 1107558400, v45
  v_fmamk_f32 v48, v43, 1107820544, v45
  v_fmamk_f32 v49, v43, 1108082688, v45
  v_fmamk_f32 v50, v43, 1108344832, v45
  v_fmamk_f32 v51, v43, 1108606976, v45
  v_fmamk_f32 v8, v43, 1108869120, v45
  v_fmamk_f32 v9, v43, 1109131264, v45
  v_cos_f32 v46, v46
  v_cos_f32 v47, v47
  v_cos_f32 v48, v48
  v_cos_f32 v49, v49
  v_cos_f32 v50, v50
  v_cos_f32 v51, v51
  v_cos_f32 v8, v8
  v_cos_f32 v9, v9
  v_cvt_pk_bf16_f32 v188, v46, v47
  v_cvt_pk_bf16_f32 v189, v48, v49
  v_cvt_pk_bf16_f32 v190, v50, v51
  v_cvt_pk_bf16_f32 v191, v8, v9
  s_lshl_b32 s76, s77, 6
  v_cvt_f32_u32 v45, s76
  s_add_u32 s77, s77, 1
  s_cmp_eq_u32 s77, 9
  s_cselect_b32 s77, 0, s77
  v_fma_f32 v45, v45, v43, v44
  v_fmamk_f32 v47, v43, 1065353216, v45
  v_fmamk_f32 v48, v43, 1073741824, v45
  v_fmamk_f32 v49, v43, 1077936128, v45
  v_fmamk_f32 v50, v43, 1082130432, v45
  v_fmamk_f32 v51, v43, 1084227584, v45
  v_fmamk_f32 v8, v43, 1086324736, v45
  v_fmamk_f32 v9, v43, 1088421888, v45
  v_cos_f32 v46, v45
  v_cos_f32 v47, v47
  v_cos_f32 v48, v48
  v_cos_f32 v49, v49
  v_cos_f32 v50, v50
  v_cos_f32 v51, v51
  v_cos_f32 v8, v8
  v_cos_f32 v9, v9
  v_cvt_pk_bf16_f32 v192, v46, v47
  v_cvt_pk_bf16_f32 v193, v48, v49
  v_cvt_pk_bf16_f32 v194, v50, v51
  v_cvt_pk_bf16_f32 v195, v8, v9
  v_fmamk_f32 v46, v43, 1107296256, v45
  v_fmamk_f32 v47, v43, 1107558400, v45
  v_fmamk_f32 v48, v43, 1107820544, v45
  v_fmamk_f32 v49, v43, 1108082688, v45
  v_fmamk_f32 v50, v43, 1108344832, v45
  v_fmamk_f32 v51, v43, 1108606976, v45
  v_fmamk_f32 v8, v43, 1108869120, v45
  v_fmamk_f32 v9, v43, 1109131264, v45
  v_cos_f32 v46, v46
  v_cos_f32 v47, v47
  v_cos_f32 v48, v48
  v_cos_f32 v49, v49
  v_cos_f32 v50, v50
  v_cos_f32 v51, v51
  v_cos_f32 v8, v8
  v_cos_f32 v9, v9
  v_cvt_pk_bf16_f32 v196, v46, v47
  v_cvt_pk_bf16_f32 v197, v48, v49
  v_cvt_pk_bf16_f32 v198, v50, v51
  v_cvt_pk_bf16_f32 v199, v8, v9
  s_waitcnt vmcnt(0)
  s_waitcnt vmcnt(0)
  s_mov_b64 exec, 1
  ds_add_u32 v56, v57
  s_mov_b64 exec, -1
  s_add_u32 s78, s78, 8
.Lfs_84:
  ds_read_b32 v58, v56
  s_waitcnt lgkmcnt(0)
  v_readfirstlane_b32 s79, v58
  s_cmp_lt_u32 s79, s78
  s_cbranch_scc1 .Lfs_84
  ds_read_b128 v[64:67], v62 offset:0
  ds_read_b128 v[68:71], v62 offset:2048
  ds_read_b128 v[72:75], v62 offset:4096
  ds_read_b128 v[76:79], v62 offset:6144
  ds_read_b128 v[80:83], v63 offset:0
  ds_read_b128 v[84:87], v63 offset:2048
  ds_read_b128 v[88:91], v63 offset:4096
  ds_read_b128 v[92:95], v63 offset:6144
  s_waitcnt lgkmcnt(7)
  ds_read_b128 v[96:99], v62 offset:8192
  ds_read_b128 v[100:103], v62 offset:10240
  ds_read_b128 v[104:107], v62 offset:12288
  ds_read_b128 v[108:111], v62 offset:14336
  ds_read_b128 v[112:115], v63 offset:8192
  ds_read_b128 v[116:119], v63 offset:10240
  ds_read_b128 v[120:123], v63 offset:12288
  ds_read_b128 v[124:127], v63 offset:14336
  s_waitcnt lgkmcnt(15)
  v_mfma_f32_16x16x32_bf16 v[200:203], v[64:67], v[128:131], 0
  v_mfma_f32_16x16x32_bf16 v[216:219], v[64:67], v[232:235], 0
  s_waitcnt lgkmcnt(14)
  v_mfma_f32_16x16x32_bf16 v[204:207], v[68:71], v[128:131], 0
  v_mfma_f32_16x16x32_bf16 v[220:223], v[68:71], v[232:235], 0
  s_waitcnt lgkmcnt(13)
  v_mfma_f32_16x16x32_bf16 v[208:211], v[72:75], v[128:131], 0
  v_mfma_f32_16x16x32_bf16 v[224:227], v[72:75], v[232:235], 0
  s_waitcnt lgkmcnt(12)
  v_mfma_f32_16x16x32_bf16 v[212:215], v[76:79], v[128:131], 0
  v_mfma_f32_16x16x32_bf16 v[228:231], v[76:79], v[232:235], 0
  s_waitcnt lgkmcnt(11)
  v_mfma_f32_16x16x32_bf16 v[200:203], v[80:83], v[132:135], v[200:203]
  v_mfma_f32_16x16x32_bf16 v[216:219], v[80:83], v[232:235], v[216:219]
  s_waitcnt lgkmcnt(10)
  v_mfma_f32_16x16x32_bf16 v[204:207], v[84:87], v[132:135], v[204:207]
  v_mfma_f32_16x16x32_bf16 v[220:223], v[84:87], v[232:235], v[220:223]
  s_waitcnt lgkmcnt(9)
  v_mfma_f32_16x16x32_bf16 v[208:211], v[88:91], v[132:135], v[208:211]
  v_mfma_f32_16x16x32_bf16 v[224:227], v[88:91], v[232:235], v[224:227]
  s_waitcnt lgkmcnt(8)
  v_mfma_f32_16x16x32_bf16 v[212:215], v[92:95], v[132:135], v[212:215]
  v_mfma_f32_16x16x32_bf16 v[228:231], v[92:95], v[232:235], v[228:231]
  s_waitcnt lgkmcnt(7)
  ds_read_b128 v[64:67], v60 offset:0
  ds_read_b128 v[68:71], v60 offset:2048
  ds_read_b128 v[72:75], v60 offset:4096
  ds_read_b128 v[76:79], v60 offset:6144
  ds_read_b128 v[80:83], v61 offset:0
  ds_read_b128 v[84:87], v61 offset:2048
  ds_read_b128 v[88:91], v61 offset:4096
  ds_read_b128 v[92:95], v61 offset:6144
  s_waitcnt lgkmcnt(15)
  v_mfma_f32_16x16x32_bf16 v[200:203], v[96:99], v[136:139], v[200:203]
  v_mfma_f32_16x16x32_bf16 v[216:219], v[96:99], v[232:235], v[216:219]
  s_waitcnt lgkmcnt(14)
  v_mfma_f32_16x16x32_bf16 v[204:207], v[100:103], v[136:139], v[204:207]
  v_mfma_f32_16x16x32_bf16 v[220:223], v[100:103], v[232:235], v[220:223]
  s_waitcnt lgkmcnt(13)
  v_mfma_f32_16x16x32_bf16 v[208:211], v[104:107], v[136:139], v[208:211]
  v_mfma_f32_16x16x32_bf16 v[224:227], v[104:107], v[232:235], v[224:227]
  s_waitcnt lgkmcnt(12)
  v_mfma_f32_16x16x32_bf16 v[212:215], v[108:111], v[136:139], v[212:215]
  v_mfma_f32_16x16x32_bf16 v[228:231], v[108:111], v[232:235], v[228:231]
  s_waitcnt lgkmcnt(11)
  v_mfma_f32_16x16x32_bf16 v[200:203], v[112:115], v[140:143], v[200:203]
  v_mfma_f32_16x16x32_bf16 v[216:219], v[112:115], v[232:235], v[216:219]
  s_waitcnt lgkmcnt(10)
  v_mfma_f32_16x16x32_bf16 v[204:207], v[116:119], v[140:143], v[204:207]
  v_mfma_f32_16x16x32_bf16 v[220:223], v[116:119], v[232:235], v[220:223]
  s_waitcnt lgkmcnt(9)
  v_mfma_f32_16x16x32_bf16 v[208:211], v[120:123], v[140:143], v[208:211]
  v_mfma_f32_16x16x32_bf16 v[224:227], v[120:123], v[232:235], v[224:227]
  s_waitcnt lgkmcnt(8)
  v_mfma_f32_16x16x32_bf16 v[212:215], v[124:127], v[140:143], v[212:215]
  v_mfma_f32_16x16x32_bf16 v[228:231], v[124:127], v[232:235], v[228:231]
  s_waitcnt lgkmcnt(7)
  ds_read_b128 v[96:99], v60 offset:8192
  ds_read_b128 v[100:103], v60 offset:10240
  ds_read_b128 v[104:107], v60 offset:12288
  ds_read_b128 v[108:111], v60 offset:14336
  ds_read_b128 v[112:115], v61 offset:8192
  ds_read_b128 v[116:119], v61 offset:10240
  ds_read_b128 v[120:123], v61 offset:12288
  ds_read_b128 v[124:127], v61 offset:14336
  s_waitcnt lgkmcnt(15)
  v_mfma_f32_16x16x32_bf16 v[200:203], v[64:67], v[144:147], v[200:203]
  v_mfma_f32_16x16x32_bf16 v[216:219], v[64:67], v[232:235], v[216:219]
  s_waitcnt lgkmcnt(14)
  v_mfma_f32_16x16x32_bf16 v[204:207], v[68:71], v[144:147], v[204:207]
  v_mfma_f32_16x16x32_bf16 v[220:223], v[68:71], v[232:235], v[220:223]
  s_waitcnt lgkmcnt(13)
  v_mfma_f32_16x16x32_bf16 v[208:211], v[72:75], v[144:147], v[208:211]
  v_mfma_f32_16x16x32_bf16 v[224:227], v[72:75], v[232:235], v[224:227]
  s_waitcnt lgkmcnt(12)
  v_mfma_f32_16x16x32_bf16 v[212:215], v[76:79], v[144:147], v[212:215]
  v_mfma_f32_16x16x32_bf16 v[228:231], v[76:79], v[232:235], v[228:231]
  s_waitcnt lgkmcnt(11)
  v_mfma_f32_16x16x32_bf16 v[200:203], v[80:83], v[148:151], v[200:203]
  v_mfma_f32_16x16x32_bf16 v[216:219], v[80:83], v[232:235], v[216:219]
  s_waitcnt lgkmcnt(10)
  v_mfma_f32_16x16x32_bf16 v[204:207], v[84:87], v[148:151], v[204:207]
  v_mfma_f32_16x16x32_bf16 v[220:223], v[84:87], v[232:235], v[220:223]
  s_waitcnt lgkmcnt(9)
  v_mfma_f32_16x16x32_bf16 v[208:211], v[88:91], v[148:151], v[208:211]
  v_mfma_f32_16x16x32_bf16 v[224:227], v[88:91], v[232:235], v[224:227]
  s_waitcnt lgkmcnt(8)
  v_mfma_f32_16x16x32_bf16 v[212:215], v[92:95], v[148:151], v[212:215]
  v_mfma_f32_16x16x32_bf16 v[228:231], v[92:95], v[232:235], v[228:231]
  s_waitcnt lgkmcnt(7)
  ds_read_b128 v[64:67], v60 offset:16384
  ds_read_b128 v[68:71], v60 offset:18432
  ds_read_b128 v[72:75], v60 offset:20480
  ds_read_b128 v[76:79], v60 offset:22528
  ds_read_b128 v[80:83], v61 offset:16384
  ds_read_b128 v[84:87], v61 offset:18432
  ds_read_b128 v[88:91], v61 offset:20480
  ds_read_b128 v[92:95], v61 offset:22528
  s_waitcnt lgkmcnt(15)
  v_mfma_f32_16x16x32_bf16 v[200:203], v[96:99], v[152:155], v[200:203]
  v_mfma_f32_16x16x32_bf16 v[216:219], v[96:99], v[232:235], v[216:219]
  s_waitcnt lgkmcnt(14)
  v_mfma_f32_16x16x32_bf16 v[204:207], v[100:103], v[152:155], v[204:207]
  v_mfma_f32_16x16x32_bf16 v[220:223], v[100:103], v[232:235], v[220:223]
  s_waitcnt lgkmcnt(13)
  v_mfma_f32_16x16x32_bf16 v[208:211], v[104:107], v[152:155], v[208:211]
  v_mfma_f32_16x16x32_bf16 v[224:227], v[104:107], v[232:235], v[224:227]
  s_waitcnt lgkmcnt(12)
  v_mfma_f32_16x16x32_bf16 v[212:215], v[108:111], v[152:155], v[212:215]
  v_mfma_f32_16x16x32_bf16 v[228:231], v[108:111], v[232:235], v[228:231]
  s_waitcnt lgkmcnt(11)
  v_mfma_f32_16x16x32_bf16 v[200:203], v[112:115], v[156:159], v[200:203]
  v_mfma_f32_16x16x32_bf16 v[216:219], v[112:115], v[232:235], v[216:219]
  s_waitcnt lgkmcnt(10)
  v_mfma_f32_16x16x32_bf16 v[204:207], v[116:119], v[156:159], v[204:207]
  v_mfma_f32_16x16x32_bf16 v[220:223], v[116:119], v[232:235], v[220:223]
  s_waitcnt lgkmcnt(9)
  v_mfma_f32_16x16x32_bf16 v[208:211], v[120:123], v[156:159], v[208:211]
  v_mfma_f32_16x16x32_bf16 v[224:227], v[120:123], v[232:235], v[224:227]
  s_waitcnt lgkmcnt(8)
  v_mfma_f32_16x16x32_bf16 v[212:215], v[124:127], v[156:159], v[212:215]
  v_mfma_f32_16x16x32_bf16 v[228:231], v[124:127], v[232:235], v[228:231]
  s_waitcnt lgkmcnt(7)
  ds_read_b128 v[96:99], v60 offset:24576
  ds_read_b128 v[100:103], v60 offset:26624
  ds_read_b128 v[104:107], v60 offset:28672
  ds_read_b128 v[108:111], v60 offset:30720
  ds_read_b128 v[112:115], v61 offset:24576
  ds_read_b128 v[116:119], v61 offset:26624
  ds_read_b128 v[120:123], v61 offset:28672
  ds_read_b128 v[124:127], v61 offset:30720
  s_waitcnt lgkmcnt(15)
  v_mfma_f32_16x16x32_bf16 v[200:203], v[64:67], v[160:163], v[200:203]
  v_mfma_f32_16x16x32_bf16 v[216:219], v[64:67], v[232:235], v[216:219]
  s_waitcnt lgkmcnt(14)
  v_mfma_f32_16x16x32_bf16 v[204:207], v[68:71], v[160:163], v[204:207]
  v_mfma_f32_16x16x32_bf16 v[220:223], v[68:71], v[232:235], v[220:223]
  s_waitcnt lgkmcnt(13)
  v_mfma_f32_16x16x32_bf16 v[208:211], v[72:75], v[160:163], v[208:211]
  v_mfma_f32_16x16x32_bf16 v[224:227], v[72:75], v[232:235], v[224:227]
  s_waitcnt lgkmcnt(12)
  v_mfma_f32_16x16x32_bf16 v[212:215], v[76:79], v[160:163], v[212:215]
  v_mfma_f32_16x16x32_bf16 v[228:231], v[76:79], v[232:235], v[228:231]
  s_waitcnt lgkmcnt(11)
  v_mfma_f32_16x16x32_bf16 v[200:203], v[80:83], v[164:167], v[200:203]
  v_mfma_f32_16x16x32_bf16 v[216:219], v[80:83], v[232:235], v[216:219]
  s_waitcnt lgkmcnt(10)
  v_mfma_f32_16x16x32_bf16 v[204:207], v[84:87], v[164:167], v[204:207]
  v_mfma_f32_16x16x32_bf16 v[220:223], v[84:87], v[232:235], v[220:223]
  s_waitcnt lgkmcnt(9)
  v_mfma_f32_16x16x32_bf16 v[208:211], v[88:91], v[164:167], v[208:211]
  v_mfma_f32_16x16x32_bf16 v[224:227], v[88:91], v[232:235], v[224:227]
  s_waitcnt lgkmcnt(8)
  v_mfma_f32_16x16x32_bf16 v[212:215], v[92:95], v[164:167], v[212:215]
  v_mfma_f32_16x16x32_bf16 v[228:231], v[92:95], v[232:235], v[228:231]
  s_waitcnt lgkmcnt(7)
  ds_read_b128 v[64:67], v60 offset:32768
  ds_read_b128 v[68:71], v60 offset:34816
  ds_read_b128 v[72:75], v60 offset:36864
  ds_read_b128 v[76:79], v60 offset:38912
  ds_read_b128 v[80:83], v61 offset:32768
  ds_read_b128 v[84:87], v61 offset:34816
  ds_read_b128 v[88:91], v61 offset:36864
  ds_read_b128 v[92:95], v61 offset:38912
  s_waitcnt lgkmcnt(15)
  v_mfma_f32_16x16x32_bf16 v[200:203], v[96:99], v[168:171], v[200:203]
  v_mfma_f32_16x16x32_bf16 v[216:219], v[96:99], v[232:235], v[216:219]
  s_waitcnt lgkmcnt(14)
  v_mfma_f32_16x16x32_bf16 v[204:207], v[100:103], v[168:171], v[204:207]
  v_mfma_f32_16x16x32_bf16 v[220:223], v[100:103], v[232:235], v[220:223]
  s_waitcnt lgkmcnt(13)
  v_mfma_f32_16x16x32_bf16 v[208:211], v[104:107], v[168:171], v[208:211]
  v_mfma_f32_16x16x32_bf16 v[224:227], v[104:107], v[232:235], v[224:227]
  s_waitcnt lgkmcnt(12)
  v_mfma_f32_16x16x32_bf16 v[212:215], v[108:111], v[168:171], v[212:215]
  v_mfma_f32_16x16x32_bf16 v[228:231], v[108:111], v[232:235], v[228:231]
  s_waitcnt lgkmcnt(11)
  v_mfma_f32_16x16x32_bf16 v[200:203], v[112:115], v[172:175], v[200:203]
  v_mfma_f32_16x16x32_bf16 v[216:219], v[112:115], v[232:235], v[216:219]
  s_waitcnt lgkmcnt(10)
  v_mfma_f32_16x16x32_bf16 v[204:207], v[116:119], v[172:175], v[204:207]
  v_mfma_f32_16x16x32_bf16 v[220:223], v[116:119], v[232:235], v[220:223]
  s_waitcnt lgkmcnt(9)
  v_mfma_f32_16x16x32_bf16 v[208:211], v[120:123], v[172:175], v[208:211]
  v_mfma_f32_16x16x32_bf16 v[224:227], v[120:123], v[232:235], v[224:227]
  s_waitcnt lgkmcnt(8)
  v_mfma_f32_16x16x32_bf16 v[212:215], v[124:127], v[172:175], v[212:215]
  v_mfma_f32_16x16x32_bf16 v[228:231], v[124:127], v[232:235], v[228:231]
  s_waitcnt lgkmcnt(7)
  ds_read_b128 v[96:99], v60 offset:40960
  ds_read_b128 v[100:103], v60 offset:43008
  ds_read_b128 v[104:107], v60 offset:45056
  ds_read_b128 v[108:111], v60 offset:47104
  ds_read_b128 v[112:115], v61 offset:40960
  ds_read_b128 v[116:119], v61 offset:43008
  ds_read_b128 v[120:123], v61 offset:45056
  ds_read_b128 v[124:127], v61 offset:47104
  s_waitcnt lgkmcnt(15)
  v_mfma_f32_16x16x32_bf16 v[200:203], v[64:67], v[176:179], v[200:203]
  v_mfma_f32_16x16x32_bf16 v[216:219], v[64:67], v[232:235], v[216:219]
  s_waitcnt lgkmcnt(14)
  v_mfma_f32_16x16x32_bf16 v[204:207], v[68:71], v[176:179], v[204:207]
  v_mfma_f32_16x16x32_bf16 v[220:223], v[68:71], v[232:235], v[220:223]
  s_waitcnt lgkmcnt(13)
  v_mfma_f32_16x16x32_bf16 v[208:211], v[72:75], v[176:179], v[208:211]
  v_mfma_f32_16x16x32_bf16 v[224:227], v[72:75], v[232:235], v[224:227]
  s_waitcnt lgkmcnt(12)
  v_mfma_f32_16x16x32_bf16 v[212:215], v[76:79], v[176:179], v[212:215]
  v_mfma_f32_16x16x32_bf16 v[228:231], v[76:79], v[232:235], v[228:231]
  s_waitcnt lgkmcnt(11)
  v_mfma_f32_16x16x32_bf16 v[200:203], v[80:83], v[180:183], v[200:203]
  v_mfma_f32_16x16x32_bf16 v[216:219], v[80:83], v[232:235], v[216:219]
  s_waitcnt lgkmcnt(10)
  v_mfma_f32_16x16x32_bf16 v[204:207], v[84:87], v[180:183], v[204:207]
  v_mfma_f32_16x16x32_bf16 v[220:223], v[84:87], v[232:235], v[220:223]
  s_waitcnt lgkmcnt(9)
  v_mfma_f32_16x16x32_bf16 v[208:211], v[88:91], v[180:183], v[208:211]
  v_mfma_f32_16x16x32_bf16 v[224:227], v[88:91], v[232:235], v[224:227]
  s_waitcnt lgkmcnt(8)
  v_mfma_f32_16x16x32_bf16 v[212:215], v[92:95], v[180:183], v[212:215]
  v_mfma_f32_16x16x32_bf16 v[228:231], v[92:95], v[232:235], v[228:231]
  s_waitcnt lgkmcnt(7)
  ds_read_b128 v[64:67], v60 offset:49152
  ds_read_b128 v[68:71], v60 offset:51200
  ds_read_b128 v[72:75], v60 offset:53248
  ds_read_b128 v[76:79], v60 offset:55296
  ds_read_b128 v[80:83], v61 offset:49152
  ds_read_b128 v[84:87], v61 offset:51200
  ds_read_b128 v[88:91], v61 offset:53248
  ds_read_b128 v[92:95], v61 offset:55296
  s_waitcnt lgkmcnt(15)
  v_mfma_f32_16x16x32_bf16 v[200:203], v[96:99], v[184:187], v[200:203]
  v_mfma_f32_16x16x32_bf16 v[216:219], v[96:99], v[232:235], v[216:219]
  s_waitcnt lgkmcnt(14)
  v_mfma_f32_16x16x32_bf16 v[204:207], v[100:103], v[184:187], v[204:207]
  v_mfma_f32_16x16x32_bf16 v[220:223], v[100:103], v[232:235], v[220:223]
  s_waitcnt lgkmcnt(13)
  v_mfma_f32_16x16x32_bf16 v[208:211], v[104:107], v[184:187], v[208:211]
  v_mfma_f32_16x16x32_bf16 v[224:227], v[104:107], v[232:235], v[224:227]
  s_waitcnt lgkmcnt(12)
  v_mfma_f32_16x16x32_bf16 v[212:215], v[108:111], v[184:187], v[212:215]
  v_mfma_f32_16x16x32_bf16 v[228:231], v[108:111], v[232:235], v[228:231]
  s_waitcnt lgkmcnt(11)
  v_mfma_f32_16x16x32_bf16 v[200:203], v[112:115], v[188:191], v[200:203]
  v_mfma_f32_16x16x32_bf16 v[216:219], v[112:115], v[232:235], v[216:219]
  s_waitcnt lgkmcnt(10)
  v_mfma_f32_16x16x32_bf16 v[204:207], v[116:119], v[188:191], v[204:207]
  v_mfma_f32_16x16x32_bf16 v[220:223], v[116:119], v[232:235], v[220:223]
  s_waitcnt lgkmcnt(9)
  v_mfma_f32_16x16x32_bf16 v[208:211], v[120:123], v[188:191], v[208:211]
  v_mfma_f32_16x16x32_bf16 v[224:227], v[120:123], v[232:235], v[224:227]
  s_waitcnt lgkmcnt(8)
  v_mfma_f32_16x16x32_bf16 v[212:215], v[124:127], v[188:191], v[212:215]
  v_mfma_f32_16x16x32_bf16 v[228:231], v[124:127], v[232:235], v[228:231]
  s_waitcnt lgkmcnt(7)
  v_mfma_f32_16x16x32_bf16 v[200:203], v[64:67], v[192:195], v[200:203]
  v_mfma_f32_16x16x32_bf16 v[216:219], v[64:67], v[232:235], v[216:219]
  s_waitcnt lgkmcnt(6)
  v_mfma_f32_16x16x32_bf16 v[204:207], v[68:71], v[192:195], v[204:207]
  v_mfma_f32_16x16x32_bf16 v[220:223], v[68:71], v[232:235], v[220:223]
  s_waitcnt lgkmcnt(5)
  v_mfma_f32_16x16x32_bf16 v[208:211], v[72:75], v[192:195], v[208:211]
  v_mfma_f32_16x16x32_bf16 v[224:227], v[72:75], v[232:235], v[224:227]
  s_waitcnt lgkmcnt(4)
  v_mfma_f32_16x16x32_bf16 v[212:215], v[76:79], v[192:195], v[212:215]
  v_mfma_f32_16x16x32_bf16 v[228:231], v[76:79], v[232:235], v[228:231]
  s_waitcnt lgkmcnt(3)
  v_mfma_f32_16x16x32_bf16 v[200:203], v[80:83], v[196:199], v[200:203]
  v_mfma_f32_16x16x32_bf16 v[216:219], v[80:83], v[232:235], v[216:219]
  s_waitcnt lgkmcnt(2)
  v_mfma_f32_16x16x32_bf16 v[204:207], v[84:87], v[196:199], v[204:207]
  v_mfma_f32_16x16x32_bf16 v[220:223], v[84:87], v[232:235], v[220:223]
  s_waitcnt lgkmcnt(1)
  v_mfma_f32_16x16x32_bf16 v[208:211], v[88:91], v[196:199], v[208:211]
  v_mfma_f32_16x16x32_bf16 v[224:227], v[88:91], v[232:235], v[224:227]
  s_waitcnt lgkmcnt(0)
  v_mfma_f32_16x16x32_bf16 v[212:215], v[92:95], v[196:199], v[212:215]
  v_mfma_f32_16x16x32_bf16 v[228:231], v[92:95], v[232:235], v[228:231]
  s_nop 6
  v_cvt_pk_bf16_f32 v80, v200, v201
  v_cvt_pk_bf16_f32 v81, v202, v203
  v_cvt_pk_bf16_f32 v82, v204, v205
  v_cvt_pk_bf16_f32 v83, v206, v207
  v_cvt_pk_bf16_f32 v84, v208, v209
  v_cvt_pk_bf16_f32 v85, v210, v211
  v_cvt_pk_bf16_f32 v86, v212, v213
  v_cvt_pk_bf16_f32 v87, v214, v215
  v_xor_b32 v88, v55, v80
  v_xor_b32 v89, v55, v81
  v_xor_b32 v90, v55, v82
  v_xor_b32 v91, v55, v83
  v_xor_b32 v92, v55, v84
  v_xor_b32 v93, v55, v85
  v_xor_b32 v94, v55, v86
  v_xor_b32 v95, v55, v87
  s_nop 1
  v_mfma_f32_16x16x32_bf16 v[96:99], v[16:19], v[88:91], 0
  v_mfma_f32_16x16x32_bf16 v[112:115], v[24:27], v[80:83], 0
  v_mfma_f32_16x16x32_bf16 v[100:103], v[20:23], v[88:91], 0
  v_mfma_f32_16x16x32_bf16 v[116:119], v[28:31], v[80:83], 0
  v_mfma_f32_16x16x32_bf16 v[104:107], v[16:19], v[92:95], 0
  v_mfma_f32_16x16x32_bf16 v[120:123], v[24:27], v[84:87], 0
  v_mfma_f32_16x16x32_bf16 v[108:111], v[20:23], v[92:95], 0
  v_mfma_f32_16x16x32_bf16 v[124:127], v[28:31], v[84:87], 0
  s_nop 7
  v_subrev_f32_dpp v96, v112, v96 row_ror:8 row_mask:0xf bank_mask:0xf
  v_subrev_f32_dpp v97, v113, v97 row_ror:8 row_mask:0xf bank_mask:0xf
  v_subrev_f32_dpp v98, v114, v98 row_ror:8 row_mask:0xf bank_mask:0xf
  v_subrev_f32_dpp v99, v115, v99 row_ror:8 row_mask:0xf bank_mask:0xf
  v_subrev_f32_dpp v100, v116, v100 row_ror:8 row_mask:0xf bank_mask:0xf
  v_subrev_f32_dpp v101, v117, v101 row_ror:8 row_mask:0xf bank_mask:0xf
  v_subrev_f32_dpp v102, v118, v102 row_ror:8 row_mask:0xf bank_mask:0xf
  v_subrev_f32_dpp v103, v119, v103 row_ror:8 row_mask:0xf bank_mask:0xf
  v_subrev_f32_dpp v104, v120, v104 row_ror:8 row_mask:0xf bank_mask:0xf
  v_subrev_f32_dpp v105, v121, v105 row_ror:8 row_mask:0xf bank_mask:0xf
  v_subrev_f32_dpp v106, v122, v106 row_ror:8 row_mask:0xf bank_mask:0xf
  v_subrev_f32_dpp v107, v123, v107 row_ror:8 row_mask:0xf bank_mask:0xf
  v_subrev_f32_dpp v108, v124, v108 row_ror:8 row_mask:0xf bank_mask:0xf
  v_subrev_f32_dpp v109, v125, v109 row_ror:8 row_mask:0xf bank_mask:0xf
  v_subrev_f32_dpp v110, v126, v110 row_ror:8 row_mask:0xf bank_mask:0xf
  v_subrev_f32_dpp v111, v127, v111 row_ror:8 row_mask:0xf bank_mask:0xf
  v_cvt_pk_bf16_f32 v64, v96, v104
  ds_write_b32 v53, v64 offset:0
  v_cvt_pk_bf16_f32 v65, v97, v105
  ds_write_b32 v53, v65 offset:128
  v_cvt_pk_bf16_f32 v66, v98, v106
  ds_write_b32 v53, v66 offset:256
  v_cvt_pk_bf16_f32 v67, v99, v107
  ds_write_b32 v53, v67 offset:384
  v_cvt_pk_bf16_f32 v68, v100, v108
  ds_write_b32 v53, v68 offset:2048
  v_cvt_pk_bf16_f32 v69, v101, v109
  ds_write_b32 v53, v69 offset:2176
  v_cvt_pk_bf16_f32 v70, v102, v110
  ds_write_b32 v53, v70 offset:2304
  v_cvt_pk_bf16_f32 v71, v103, v111
  ds_write_b32 v53, v71 offset:2432
  v_cvt_pk_bf16_f32 v80, v216, v217
  v_cvt_pk_bf16_f32 v81, v218, v219
  v_cvt_pk_bf16_f32 v82, v220, v221
  v_cvt_pk_bf16_f32 v83, v222, v223
  v_cvt_pk_bf16_f32 v84, v224, v225
  v_cvt_pk_bf16_f32 v85, v226, v227
  v_cvt_pk_bf16_f32 v86, v228, v229
  v_cvt_pk_bf16_f32 v87, v230, v231
  v_xor_b32 v88, v55, v80
  v_xor_b32 v89, v55, v81
  v_xor_b32 v90, v55, v82
  v_xor_b32 v91, v55, v83
  v_xor_b32 v92, v55, v84
  v_xor_b32 v93, v55, v85
  v_xor_b32 v94, v55, v86
  v_xor_b32 v95, v55, v87
  s_nop 1
  v_mfma_f32_16x16x32_bf16 v[96:99], v[16:19], v[88:91], 0
  v_mfma_f32_16x16x32_bf16 v[112:115], v[24:27], v[80:83], 0
  v_mfma_f32_16x16x32_bf16 v[100:103], v[20:23], v[88:91], 0
  v_mfma_f32_16x16x32_bf16 v[116:119], v[28:31], v[80:83], 0
  v_mfma_f32_16x16x32_bf16 v[104:107], v[16:19], v[92:95], 0
  v_mfma_f32_16x16x32_bf16 v[120:123], v[24:27], v[84:87], 0
  v_mfma_f32_16x16x32_bf16 v[108:111], v[20:23], v[92:95], 0
  v_mfma_f32_16x16x32_bf16 v[124:127], v[28:31], v[84:87], 0
  s_nop 7
  v_subrev_f32_dpp v96, v112, v96 row_ror:8 row_mask:0xf bank_mask:0xf
  v_subrev_f32_dpp v97, v113, v97 row_ror:8 row_mask:0xf bank_mask:0xf
  v_subrev_f32_dpp v98, v114, v98 row_ror:8 row_mask:0xf bank_mask:0xf
  v_subrev_f32_dpp v99, v115, v99 row_ror:8 row_mask:0xf bank_mask:0xf
  v_subrev_f32_dpp v100, v116, v100 row_ror:8 row_mask:0xf bank_mask:0xf
  v_subrev_f32_dpp v101, v117, v101 row_ror:8 row_mask:0xf bank_mask:0xf
  v_subrev_f32_dpp v102, v118, v102 row_ror:8 row_mask:0xf bank_mask:0xf
  v_subrev_f32_dpp v103, v119, v103 row_ror:8 row_mask:0xf bank_mask:0xf
  v_subrev_f32_dpp v104, v120, v104 row_ror:8 row_mask:0xf bank_mask:0xf
  v_subrev_f32_dpp v105, v121, v105 row_ror:8 row_mask:0xf bank_mask:0xf
  v_subrev_f32_dpp v106, v122, v106 row_ror:8 row_mask:0xf bank_mask:0xf
  v_subrev_f32_dpp v107, v123, v107 row_ror:8 row_mask:0xf bank_mask:0xf
  v_subrev_f32_dpp v108, v124, v108 row_ror:8 row_mask:0xf bank_mask:0xf
  v_subrev_f32_dpp v109, v125, v109 row_ror:8 row_mask:0xf bank_mask:0xf
  v_subrev_f32_dpp v110, v126, v110 row_ror:8 row_mask:0xf bank_mask:0xf
  v_subrev_f32_dpp v111, v127, v111 row_ror:8 row_mask:0xf bank_mask:0xf
  v_cvt_pk_bf16_f32 v64, v96, v104
  ds_write_b32 v53, v64 offset:8192
  v_cvt_pk_bf16_f32 v65, v97, v105
  ds_write_b32 v53, v65 offset:8320
  v_cvt_pk_bf16_f32 v66, v98, v106
  ds_write_b32 v53, v66 offset:8448
  v_cvt_pk_bf16_f32 v67, v99, v107
  ds_write_b32 v53, v67 offset:8576
  v_cvt_pk_bf16_f32 v68, v100, v108
  ds_write_b32 v53, v68 offset:10240
  v_cvt_pk_bf16_f32 v69, v101, v109
  ds_write_b32 v53, v69 offset:10368
  v_cvt_pk_bf16_f32 v70, v102, v110
  ds_write_b32 v53, v70 offset:10496
  v_cvt_pk_bf16_f32 v71, v103, v111
  ds_write_b32 v53, v71 offset:10624
  s_waitcnt lgkmcnt(0)
  s_mov_b64 exec, 1
  ds_add_u32 v56, v57
  s_mov_b64 exec, -1
  s_add_u32 s78, s78, 8
.Lfs_85:
  ds_read_b32 v58, v56
  s_waitcnt lgkmcnt(0)
  v_readfirstlane_b32 s79, v58
  s_cmp_lt_u32 s79, s78
  s_cbranch_scc1 .Lfs_85
  ds_read_b128 v[218:221], v59 offset:0
  ds_read_b128 v[222:225], v59 offset:1024
  ds_read_b128 v[226:229], v59 offset:8192
  ds_read_b128 v[230:233], v59 offset:9216
  v_mov_b32 v242, v52
  s_waitcnt lgkmcnt(0)
  s_setprio 0
  s_mul_i32 s73, s94, 9
  s_add_u32 s71, s73, s97
  s_mul_i32 s71, s71, 8448
  s_add_u32 s73, s73, 8
  s_mul_i32 s73, s73, 8448
  s_lshl_b32 s74, s97, 10
  s_mul_i32 s75, s97, 1056
  s_branch .Ll_s0
.Lc_spare:
  s_mov_b32 s70, s3
  s_lshl_b32 s72, s3, 11
  s_mov_b32 s78, 0
  v_mov_b32 v4, 0
  v_mov_b32 v5, 0
  s_add_u32 s80, s92, 0
  s_and_b32 s79, s80, 3
  s_lshl_b32 s81, s68, 2
  s_add_u32 s79, s79, s81
  s_lshr_b32 s80, s80, 2
  v_lshrrev_b32 v6, 3, v0
  v_lshrrev_b32 v7, 2, v6
  v_and_b32 v8, 3, v6
  v_lshl_add_u32 v8, v7, 3, v8
  s_and_b32 s81, s70, 1
  s_lshl_b32 s81, s81, 8
  s_lshr_b32 s82, s70, 1
  s_add_u32 s81, s81, s82
  s_lshl_b32 s82, s79, 1
  s_add_u32 s81, s81, s82
  v_lshlrev_b32 v8, 6, v8
  v_add_u32 v8, s81, v8
  v_mul_u32_u24 v8, 1152, v8
  v_add_u32 v40, v8, v4
  v_add_u32 v41, 1178624, v8
  v_add_u32 v41, v41, v5
  s_lshl_b32 s81, s80, 5
  s_lshl_b32 s82, s70, 3
  s_add_u32 s81, s81, s82
  v_and_b32 v8, 7, v0
  v_add_u32 v42, s81, v8
  s_lshl_b32 s81, s70, 4
  v_add_u32 v8, s81, v6
  v_mul_u32_u24 v8, 40960, v8
  v_and_b32 v7, 7, v0
  v_lshl_add_u32 v8, v7, 4, v8
  s_mul_i32 s81, s79, 1280
  s_lshl_b32 s82, s80, 7
  s_add_u32 s81, s81, s82
  s_add_u32 s81, s81, 7340032
  v_add_u32 v52, s81, v8
  s_waitcnt lgkmcnt(0)
  s_barrier
  s_setprio 3
  v_and_b32 v6, 15, v0
  v_lshrrev_b32 v7, 1, v6
  v_lshrrev_b32 v8, 4, v0
  v_xor_b32 v7, v7, v8
  v_lshlrev_b32 v6, 7, v6
  v_lshl_add_u32 v60, v7, 4, v6
  v_xor_b32 v61, 64, v60
  v_add_u32 v62, 131072, v60
  v_add_u32 v63, 131072, v61
  v_add_u32 v60, 40960, v60
  v_add_u32 v61, 40960, v61
  v_mov_b32 v56, 162816
  v_mov_b32 v57, 1
  v_bfe_u32 v6, v0, 3, 1
  v_mul_u32_u24 v55, 0x8000, v6
  v_lshl_or_b32 v55, v55, 16, v55
  v_lshlrev_b32 v6, 12, v6
  v_lshl_add_u32 v6, v8, 9, v6
  v_and_b32 v7, 7, v0
  v_lshl_add_u32 v6, v7, 2, v6
  s_lshl_b32 s79, s70, 5
  s_add_u32 s79, s79, 114688
  v_add_u32 v53, s79, v6
  s_add_u32 s79, s72, 114688
  v_lshlrev_b32 v6, 4, v0
  v_add_u32 v59, s79, v6
  v_and_b32 v2, 15, v0
  v_lshlrev_b32 v2, 18, v2
  v_lshrrev_b32 v3, 4, v0
  v_lshl_add_u32 v2, v3, 4, v2
  s_mov_b32 s79, 4194304
  buffer_load_dwordx4 v[16:19], v2, s[52:55], 0 offen
  buffer_load_dwordx4 v[20:23], v2, s[52:55], s79 offen
  buffer_load_dwordx4 v[24:27], v2, s[56:59], 0 offen
  buffer_load_dwordx4 v[28:31], v2, s[56:59], s79 offen
  v_cvt_f32_u32 v43, v42
  v_and_b32 v6, 1, v42
  v_lshlrev_b32 v6, 1, v6
  v_bfe_u32 v7, v0, 3, 1
  v_add_u32 v6, v6, v7
  v_cvt_f32_u32 v6, v6
  v_mul_f32 v43, 987991609, v43
  v_mul_f32 v6, 0x3e800000, v6
  v_lshrrev_b32 v7, 4, v0
  v_lshlrev_b32 v7, 3, v7
  v_subrev_u32 v7, 288, v7
  v_cvt_f32_i32 v7, v7
  v_fma_f32 v44, v7, v43, v6
  s_mov_b32 s77, s99
  s_lshl_b32 s76, s77, 6
  v_cvt_f32_u32 v45, s76
  s_add_u32 s77, s77, 1
  s_cmp_eq_u32 s77, 9
  s_cselect_b32 s77, 0, s77
  v_fma_f32 v45, v45, v43, v44
  v_fmamk_f32 v47, v43, 1065353216, v45
  v_fmamk_f32 v48, v43, 1073741824, v45
  v_fmamk_f32 v49, v43, 1077936128, v45
  v_fmamk_f32 v50, v43, 1082130432, v45
  v_fmamk_f32 v51, v43, 1084227584, v45
  v_fmamk_f32 v8, v43, 1086324736, v45
  v_fmamk_f32 v9, v43, 1088421888, v45
  v_cos_f32 v46, v45
  v_cos_f32 v47, v47
  v_cos_f32 v48, v48
  v_cos_f32 v49, v49
  v_cos_f32 v50, v50
  v_cos_f32 v51, v51
  v_cos_f32 v8, v8
  v_cos_f32 v9, v9
  v_cvt_pk_bf16_f32 v128, v46, v47
  v_cvt_pk_bf16_f32 v129, v48, v49
  v_cvt_pk_bf16_f32 v130, v50, v51
  v_cvt_pk_bf16_f32 v131, v8, v9
  v_fmamk_f32 v46, v43, 1107296256, v45
  v_fmamk_f32 v47, v43, 1107558400, v45
  v_fmamk_f32 v48, v43, 1107820544, v45
  v_fmamk_f32 v49, v43, 1108082688, v45
  v_fmamk_f32 v50, v43, 1108344832, v45
  v_fmamk_f32 v51, v43, 1108606976, v45
  v_fmamk_f32 v8, v43, 1108869120, v45
  v_fmamk_f32 v9, v43, 1109131264, v45
  v_cos_f32 v46, v46
  v_cos_f32 v47, v47
  v_cos_f32 v48, v48
  v_cos_f32 v49, v49
  v_cos_f32 v50, v50
  v_cos_f32 v51, v51
  v_cos_f32 v8, v8
  v_cos_f32 v9, v9
  v_cvt_pk_bf16_f32 v132, v46, v47
  v_cvt_pk_bf16_f32 v133, v48, v49
  v_cvt_pk_bf16_f32 v134, v50, v51
  v_cvt_pk_bf16_f32 v135, v8, v9
  s_lshl_b32 s76, s77, 6
  v_cvt_f32_u32 v45, s76
  s_add_u32 s77, s77, 1
  s_cmp_eq_u32 s77, 9
  s_cselect_b32 s77, 0, s77
  v_fma_f32 v45, v45, v43, v44
  v_fmamk_f32 v47, v43, 1065353216, v45
  v_fmamk_f32 v48, v43, 1073741824, v45
  v_fmamk_f32 v49, v43, 1077936128, v45
  v_fmamk_f32 v50, v43, 1082130432, v45
  v_fmamk_f32 v51, v43, 1084227584, v45
  v_fmamk_f32 v8, v43, 1086324736, v45
  v_fmamk_f32 v9, v43, 1088421888, v45
  v_cos_f32 v46, v45
  v_cos_f32 v47, v47
  v_cos_f32 v48, v48
  v_cos_f32 v49, v49
  v_cos_f32 v50, v50
  v_cos_f32 v51, v51
  v_cos_f32 v8, v8
  v_cos_f32 v9, v9
  v_cvt_pk_bf16_f32 v136, v46, v47
  v_cvt_pk_bf16_f32 v137, v48, v49
  v_cvt_pk_bf16_f32 v138, v50, v51
  v_cvt_pk_bf16_f32 v139, v8, v9
  v_fmamk_f32 v46, v43, 1107296256, v45
  v_fmamk_f32 v47, v43, 1107558400, v45
  v_fmamk_f32 v48, v43, 1107820544, v45
  v_fmamk_f32 v49, v43, 1108082688, v45
  v_fmamk_f32 v50, v43, 1108344832, v45
  v_fmamk_f32 v51, v43, 1108606976, v45
  v_fmamk_f32 v8, v43, 1108869120, v45
  v_fmamk_f32 v9, v43, 1109131264, v45
  v_cos_f32 v46, v46
  v_cos_f32 v47, v47
  v_cos_f32 v48, v48
  v_cos_f32 v49, v49
  v_cos_f32 v50, v50
  v_cos_f32 v51, v51
  v_cos_f32 v8, v8
  v_cos_f32 v9, v9
  v_cvt_pk_bf16_f32 v140, v46, v47
  v_cvt_pk_bf16_f32 v141, v48, v49
  v_cvt_pk_bf16_f32 v142, v50, v51
  v_cvt_pk_bf16_f32 v143, v8, v9
  s_lshl_b32 s76, s77, 6
  v_cvt_f32_u32 v45, s76
  s_add_u32 s77, s77, 1
  s_cmp_eq_u32 s77, 9
  s_cselect_b32 s77, 0, s77
  v_fma_f32 v45, v45, v43, v44
  v_fmamk_f32 v47, v43, 1065353216, v45
  v_fmamk_f32 v48, v43, 1073741824, v45
  v_fmamk_f32 v49, v43, 1077936128, v45
  v_fmamk_f32 v50, v43, 1082130432, v45
  v_fmamk_f32 v51, v43, 1084227584, v45
  v_fmamk_f32 v8, v43, 1086324736, v45
  v_fmamk_f32 v9, v43, 1088421888, v45
  v_cos_f32 v46, v45
  v_cos_f32 v47, v47
  v_cos_f32 v48, v48
  v_cos_f32 v49, v49
  v_cos_f32 v50, v50
  v_cos_f32 v51, v51
  v_cos_f32 v8, v8
  v_cos_f32 v9, v9
  v_cvt_pk_bf16_f32 v144, v46, v47
  v_cvt_pk_bf16_f32 v145, v48, v49
  v_cvt_pk_bf16_f32 v146, v50, v51
  v_cvt_pk_bf16_f32 v147, v8, v9
  v_fmamk_f32 v46, v43, 1107296256, v45
  v_fmamk_f32 v47, v43, 1107558400, v45
  v_fmamk_f32 v48, v43, 1107820544, v45
  v_fmamk_f32 v49, v43, 1108082688, v45
  v_fmamk_f32 v50, v43, 1108344832, v45
  v_fmamk_f32 v51, v43, 1108606976, v45
  v_fmamk_f32 v8, v43, 1108869120, v45
  v_fmamk_f32 v9, v43, 1109131264, v45
  v_cos_f32 v46, v46
  v_cos_f32 v47, v47
  v_cos_f32 v48, v48
  v_cos_f32 v49, v49
  v_cos_f32 v50, v50
  v_cos_f32 v51, v51
  v_cos_f32 v8, v8
  v_cos_f32 v9, v9
  v_cvt_pk_bf16_f32 v148, v46, v47
  v_cvt_pk_bf16_f32 v149, v48, v49
  v_cvt_pk_bf16_f32 v150, v50, v51
  v_cvt_pk_bf16_f32 v151, v8, v9
  s_lshl_b32 s76, s77, 6
  v_cvt_f32_u32 v45, s76
  s_add_u32 s77, s77, 1
  s_cmp_eq_u32 s77, 9
  s_cselect_b32 s77, 0, s77
  v_fma_f32 v45, v45, v43, v44
  v_fmamk_f32 v47, v43, 1065353216, v45
  v_fmamk_f32 v48, v43, 1073741824, v45
  v_fmamk_f32 v49, v43, 1077936128, v45
  v_fmamk_f32 v50, v43, 1082130432, v45
  v_fmamk_f32 v51, v43, 1084227584, v45
  v_fmamk_f32 v8, v43, 1086324736, v45
  v_fmamk_f32 v9, v43, 1088421888, v45
  v_cos_f32 v46, v45
  v_cos_f32 v47, v47
  v_cos_f32 v48, v48
  v_cos_f32 v49, v49
  v_cos_f32 v50, v50
  v_cos_f32 v51, v51
  v_cos_f32 v8, v8
  v_cos_f32 v9, v9
  v_cvt_pk_bf16_f32 v152, v46, v47
  v_cvt_pk_bf16_f32 v153, v48, v49
  v_cvt_pk_bf16_f32 v154, v50, v51
  v_cvt_pk_bf16_f32 v155, v8, v9
  v_fmamk_f32 v46, v43, 1107296256, v45
  v_fmamk_f32 v47, v43, 1107558400, v45
  v_fmamk_f32 v48, v43, 1107820544, v45
  v_fmamk_f32 v49, v43, 1108082688, v45
  v_fmamk_f32 v50, v43, 1108344832, v45
  v_fmamk_f32 v51, v43, 1108606976, v45
  v_fmamk_f32 v8, v43, 1108869120, v45
  v_fmamk_f32 v9, v43, 1109131264, v45
  v_cos_f32 v46, v46
  v_cos_f32 v47, v47
  v_cos_f32 v48, v48
  v_cos_f32 v49, v49
  v_cos_f32 v50, v50
  v_cos_f32 v51, v51
  v_cos_f32 v8, v8
  v_cos_f32 v9, v9
  v_cvt_pk_bf16_f32 v156, v46, v47
  v_cvt_pk_bf16_f32 v157, v48, v49
  v_cvt_pk_bf16_f32 v158, v50, v51
  v_cvt_pk_bf16_f32 v159, v8, v9
  s_lshl_b32 s76, s77, 6
  v_cvt_f32_u32 v45, s76
  s_add_u32 s77, s77, 1
  s_cmp_eq_u32 s77, 9
  s_cselect_b32 s77, 0, s77
  v_fma_f32 v45, v45, v43, v44
  v_fmamk_f32 v47, v43, 1065353216, v45
  v_fmamk_f32 v48, v43, 1073741824, v45
  v_fmamk_f32 v49, v43, 1077936128, v45
  v_fmamk_f32 v50, v43, 1082130432, v45
  v_fmamk_f32 v51, v43, 1084227584, v45
  v_fmamk_f32 v8, v43, 1086324736, v45
  v_fmamk_f32 v9, v43, 1088421888, v45
  v_cos_f32 v46, v45
  v_cos_f32 v47, v47
  v_cos_f32 v48, v48
  v_cos_f32 v49, v49
  v_cos_f32 v50, v50
  v_cos_f32 v51, v51
  v_cos_f32 v8, v8
  v_cos_f32 v9, v9
  v_cvt_pk_bf16_f32 v160, v46, v47
  v_cvt_pk_bf16_f32 v161, v48, v49
  v_cvt_pk_bf16_f32 v162, v50, v51
  v_cvt_pk_bf16_f32 v163, v8, v9
  v_fmamk_f32 v46, v43, 1107296256, v45
  v_fmamk_f32 v47, v43, 1107558400, v45
  v_fmamk_f32 v48, v43, 1107820544, v45
  v_fmamk_f32 v49, v43, 1108082688, v45
  v_fmamk_f32 v50, v43, 1108344832, v45
  v_fmamk_f32 v51, v43, 1108606976, v45
  v_fmamk_f32 v8, v43, 1108869120, v45
  v_fmamk_f32 v9, v43, 1109131264, v45
  v_cos_f32 v46, v46
  v_cos_f32 v47, v47
  v_cos_f32 v48, v48
  v_cos_f32 v49, v49
  v_cos_f32 v50, v50
  v_cos_f32 v51, v51
  v_cos_f32 v8, v8
  v_cos_f32 v9, v9
  v_cvt_pk_bf16_f32 v164, v46, v47
  v_cvt_pk_bf16_f32 v165, v48, v49
  v_cvt_pk_bf16_f32 v166, v50, v51
  v_cvt_pk_bf16_f32 v167, v8, v9
  s_lshl_b32 s76, s77, 6
  v_cvt_f32_u32 v45, s76
  s_add_u32 s77, s77, 1
  s_cmp_eq_u32 s77, 9
  s_cselect_b32 s77, 0, s77
  v_fma_f32 v45, v45, v43, v44
  v_fmamk_f32 v47, v43, 1065353216, v45
  v_fmamk_f32 v48, v43, 1073741824, v45
  v_fmamk_f32 v49, v43, 1077936128, v45
  v_fmamk_f32 v50, v43, 1082130432, v45
  v_fmamk_f32 v51, v43, 1084227584, v45
  v_fmamk_f32 v8, v43, 1086324736, v45
  v_fmamk_f32 v9, v43, 1088421888, v45
  v_cos_f32 v46, v45
  v_cos_f32 v47, v47
  v_cos_f32 v48, v48
  v_cos_f32 v49, v49
  v_cos_f32 v50, v50
  v_cos_f32 v51, v51
  v_cos_f32 v8, v8
  v_cos_f32 v9, v9
  v_cvt_pk_bf16_f32 v168, v46, v47
  v_cvt_pk_bf16_f32 v169, v48, v49
  v_cvt_pk_bf16_f32 v170, v50, v51
  v_cvt_pk_bf16_f32 v171, v8, v9
  v_fmamk_f32 v46, v43, 1107296256, v45
  v_fmamk_f32 v47, v43, 1107558400, v45
  v_fmamk_f32 v48, v43, 1107820544, v45
  v_fmamk_f32 v49, v43, 1108082688, v45
  v_fmamk_f32 v50, v43, 1108344832, v45
  v_fmamk_f32 v51, v43, 1108606976, v45
  v_fmamk_f32 v8, v43, 1108869120, v45
  v_fmamk_f32 v9, v43, 1109131264, v45
  v_cos_f32 v46, v46
  v_cos_f32 v47, v47
  v_cos_f32 v48, v48
  v_cos_f32 v49, v49
  v_cos_f32 v50, v50
  v_cos_f32 v51, v51
  v_cos_f32 v8, v8
  v_cos_f32 v9, v9
  v_cvt_pk_bf16_f32 v172, v46, v47
  v_cvt_pk_bf16_f32 v173, v48, v49
  v_cvt_pk_bf16_f32 v174, v50, v51
  v_cvt_pk_bf16_f32 v175, v8, v9
  s_lshl_b32 s76, s77, 6
  v_cvt_f32_u32 v45, s76
  s_add_u32 s77, s77, 1
  s_cmp_eq_u32 s77, 9
  s_cselect_b32 s77, 0, s77
  v_fma_f32 v45, v45, v43, v44
  v_fmamk_f32 v47, v43, 1065353216, v45
  v_fmamk_f32 v48, v43, 1073741824, v45
  v_fmamk_f32 v49, v43, 1077936128, v45
  v_fmamk_f32 v50, v43, 1082130432, v45
  v_fmamk_f32 v51, v43, 1084227584, v45
  v_fmamk_f32 v8, v43, 1086324736, v45
  v_fmamk_f32 v9, v43, 1088421888, v45
  v_cos_f32 v46, v45
  v_cos_f32 v47, v47
  v_cos_f32 v48, v48
  v_cos_f32 v49, v49
  v_cos_f32 v50, v50
  v_cos_f32 v51, v51
  v_cos_f32 v8, v8
  v_cos_f32 v9, v9
  v_cvt_pk_bf16_f32 v176, v46, v47
  v_cvt_pk_bf16_f32 v177, v48, v49
  v_cvt_pk_bf16_f32 v178, v50, v51
  v_cvt_pk_bf16_f32 v179, v8, v9
  v_fmamk_f32 v46, v43, 1107296256, v45
  v_fmamk_f32 v47, v43, 1107558400, v45
  v_fmamk_f32 v48, v43, 1107820544, v45
  v_fmamk_f32 v49, v43, 1108082688, v45
  v_fmamk_f32 v50, v43, 1108344832, v45
  v_fmamk_f32 v51, v43, 1108606976, v45
  v_fmamk_f32 v8, v43, 1108869120, v45
  v_fmamk_f32 v9, v43, 1109131264, v45
  v_cos_f32 v46, v46
  v_cos_f32 v47, v47
  v_cos_f32 v48, v48
  v_cos_f32 v49, v49
  v_cos_f32 v50, v50
  v_cos_f32 v51, v51
  v_cos_f32 v8, v8
  v_cos_f32 v9, v9
  v_cvt_pk_bf16_f32 v180, v46, v47
  v_cvt_pk_bf16_f32 v181, v48, v49
  v_cvt_pk_bf16_f32 v182, v50, v51
  v_cvt_pk_bf16_f32 v183, v8, v9
  s_lshl_b32 s76, s77, 6
  v_cvt_f32_u32 v45, s76
  s_add_u32 s77, s77, 1
  s_cmp_eq_u32 s77, 9
  s_cselect_b32 s77, 0, s77
  v_fma_f32 v45, v45, v43, v44
  v_fmamk_f32 v47, v43, 1065353216, v45
  v_fmamk_f32 v48, v43, 1073741824, v45
  v_fmamk_f32 v49, v43, 1077936128, v45
  v_fmamk_f32 v50, v43, 1082130432, v45
  v_fmamk_f32 v51, v43, 1084227584, v45
  v_fmamk_f32 v8, v43, 1086324736, v45
  v_fmamk_f32 v9, v43, 1088421888, v45
  v_cos_f32 v46, v45
  v_cos_f32 v47, v47
  v_cos_f32 v48, v48
  v_cos_f32 v49, v49
  v_cos_f32 v50, v50
  v_cos_f32 v51, v51
  v_cos_f32 v8, v8
  v_cos_f32 v9, v9
  v_cvt_pk_bf16_f32 v184, v46, v47
  v_cvt_pk_bf16_f32 v185, v48, v49
  v_cvt_pk_bf16_f32 v186, v50, v51
  v_cvt_pk_bf16_f32 v187, v8, v9
  v_fmamk_f32 v46, v43, 1107296256, v45
  v_fmamk_f32 v47, v43, 1107558400, v45
  v_fmamk_f32 v48, v43, 1107820544, v45
  v_fmamk_f32 v49, v43, 1108082688, v45
  v_fmamk_f32 v50, v43, 1108344832, v45
  v_fmamk_f32 v51, v43, 1108606976, v45
  v_fmamk_f32 v8, v43, 1108869120, v45
  v_fmamk_f32 v9, v43, 1109131264, v45
  v_cos_f32 v46, v46
  v_cos_f32 v47, v47
  v_cos_f32 v48, v48
  v_cos_f32 v49, v49
  v_cos_f32 v50, v50
  v_cos_f32 v51, v51
  v_cos_f32 v8, v8
  v_cos_f32 v9, v9
  v_cvt_pk_bf16_f32 v188, v46, v47
  v_cvt_pk_bf16_f32 v189, v48, v49
  v_cvt_pk_bf16_f32 v190, v50, v51
  v_cvt_pk_bf16_f32 v191, v8, v9
  s_lshl_b32 s76, s77, 6
  v_cvt_f32_u32 v45, s76
  s_add_u32 s77, s77, 1
  s_cmp_eq_u32 s77, 9
  s_cselect_b32 s77, 0, s77
  v_fma_f32 v45, v45, v43, v44
  v_fmamk_f32 v47, v43, 1065353216, v45
  v_fmamk_f32 v48, v43, 1073741824, v45
  v_fmamk_f32 v49, v43, 1077936128, v45
  v_fmamk_f32 v50, v43, 1082130432, v45
  v_fmamk_f32 v51, v43, 1084227584, v45
  v_fmamk_f32 v8, v43, 1086324736, v45
  v_fmamk_f32 v9, v43, 1088421888, v45
  v_cos_f32 v46, v45
  v_cos_f32 v47, v47
  v_cos_f32 v48, v48
  v_cos_f32 v49, v49
  v_cos_f32 v50, v50
  v_cos_f32 v51, v51
  v_cos_f32 v8, v8
  v_cos_f32 v9, v9
  v_cvt_pk_bf16_f32 v192, v46, v47
  v_cvt_pk_bf16_f32 v193, v48, v49
  v_cvt_pk_bf16_f32 v194, v50, v51
  v_cvt_pk_bf16_f32 v195, v8, v9
  v_fmamk_f32 v46, v43, 1107296256, v45
  v_fmamk_f32 v47, v43, 1107558400, v45
  v_fmamk_f32 v48, v43, 1107820544, v45
  v_fmamk_f32 v49, v43, 1108082688, v45
  v_fmamk_f32 v50, v43, 1108344832, v45
  v_fmamk_f32 v51, v43, 1108606976, v45
  v_fmamk_f32 v8, v43, 1108869120, v45
  v_fmamk_f32 v9, v43, 1109131264, v45
  v_cos_f32 v46, v46
  v_cos_f32 v47, v47
  v_cos_f32 v48, v48
  v_cos_f32 v49, v49
  v_cos_f32 v50, v50
  v_cos_f32 v51, v51
  v_cos_f32 v8, v8
  v_cos_f32 v9, v9
  v_cvt_pk_bf16_f32 v196, v46, v47
  v_cvt_pk_bf16_f32 v197, v48, v49
  v_cvt_pk_bf16_f32 v198, v50, v51
  v_cvt_pk_bf16_f32 v199, v8, v9
  v_mov_b32 v2, 0
  buffer_load_dwordx2 v[4:5], v2, s[84:87], 0 offen sc1
  s_mov_b64 exec, 1
  ds_add_u32 v56, v57
  s_mov_b64 exec, -1
  s_add_u32 s78, s78, 8
  s_setprio 1
  v_mov_b32 v6, 162976
.Lsp_86:
  ds_read_b32 v7, v6
  s_waitcnt lgkmcnt(0)
  v_readfirstlane_b32 s79, v7
  s_cmp_lt_u32 s79, 4
  s_cbranch_scc1 .Lsp_86
  ds_read_b128 v[64:67], v62 offset:0
  ds_read_b128 v[68:71], v62 offset:2048
  ds_read_b128 v[72:75], v62 offset:4096
  ds_read_b128 v[76:79], v62 offset:6144
  ds_read_b128 v[80:83], v63 offset:0
  ds_read_b128 v[84:87], v63 offset:2048
  ds_read_b128 v[88:91], v63 offset:4096
  ds_read_b128 v[92:95], v63 offset:6144
  s_waitcnt lgkmcnt(7)
  ds_read_b128 v[96:99], v62 offset:8192
  ds_read_b128 v[100:103], v62 offset:10240
  ds_read_b128 v[104:107], v62 offset:12288
  ds_read_b128 v[108:111], v62 offset:14336
  ds_read_b128 v[112:115], v63 offset:8192
  ds_read_b128 v[116:119], v63 offset:10240
  ds_read_b128 v[120:123], v63 offset:12288
  ds_read_b128 v[124:127], v63 offset:14336
  s_waitcnt lgkmcnt(15)
  v_mfma_f32_16x16x32_bf16 v[200:203], v[64:67], v[128:131], 0
  s_waitcnt lgkmcnt(14)
  v_mfma_f32_16x16x32_bf16 v[204:207], v[68:71], v[128:131], 0
  s_waitcnt lgkmcnt(13)
  v_mfma_f32_16x16x32_bf16 v[208:211], v[72:75], v[128:131], 0
  s_waitcnt lgkmcnt(12)
  v_mfma_f32_16x16x32_bf16 v[212:215], v[76:79], v[128:131], 0
  s_waitcnt lgkmcnt(11)
  v_mfma_f32_16x16x32_bf16 v[200:203], v[80:83], v[132:135], v[200:203]
  s_waitcnt lgkmcnt(10)
  v_mfma_f32_16x16x32_bf16 v[204:207], v[84:87], v[132:135], v[204:207]
  s_waitcnt lgkmcnt(9)
  v_mfma_f32_16x16x32_bf16 v[208:211], v[88:91], v[132:135], v[208:211]
  s_waitcnt lgkmcnt(8)
  v_mfma_f32_16x16x32_bf16 v[212:215], v[92:95], v[132:135], v[212:215]
  s_waitcnt lgkmcnt(7)
  ds_read_b128 v[64:67], v60 offset:0
  ds_read_b128 v[68:71], v60 offset:2048
  ds_read_b128 v[72:75], v60 offset:4096
  ds_read_b128 v[76:79], v60 offset:6144
  ds_read_b128 v[80:83], v61 offset:0
  ds_read_b128 v[84:87], v61 offset:2048
  ds_read_b128 v[88:91], v61 offset:4096
  ds_read_b128 v[92:95], v61 offset:6144
  s_waitcnt lgkmcnt(15)
  v_mfma_f32_16x16x32_bf16 v[200:203], v[96:99], v[136:139], v[200:203]
  s_waitcnt lgkmcnt(14)
  v_mfma_f32_16x16x32_bf16 v[204:207], v[100:103], v[136:139], v[204:207]
  s_waitcnt lgkmcnt(13)
  v_mfma_f32_16x16x32_bf16 v[208:211], v[104:107], v[136:139], v[208:211]
  s_waitcnt lgkmcnt(12)
  v_mfma_f32_16x16x32_bf16 v[212:215], v[108:111], v[136:139], v[212:215]
  s_waitcnt lgkmcnt(11)
  v_mfma_f32_16x16x32_bf16 v[200:203], v[112:115], v[140:143], v[200:203]
  s_waitcnt lgkmcnt(10)
  v_mfma_f32_16x16x32_bf16 v[204:207], v[116:119], v[140:143], v[204:207]
  s_waitcnt lgkmcnt(9)
  v_mfma_f32_16x16x32_bf16 v[208:211], v[120:123], v[140:143], v[208:211]
  s_waitcnt lgkmcnt(8)
  v_mfma_f32_16x16x32_bf16 v[212:215], v[124:127], v[140:143], v[212:215]
  s_waitcnt lgkmcnt(7)
  ds_read_b128 v[96:99], v60 offset:8192
  ds_read_b128 v[100:103], v60 offset:10240
  ds_read_b128 v[104:107], v60 offset:12288
  ds_read_b128 v[108:111], v60 offset:14336
  ds_read_b128 v[112:115], v61 offset:8192
  ds_read_b128 v[116:119], v61 offset:10240
  ds_read_b128 v[120:123], v61 offset:12288
  ds_read_b128 v[124:127], v61 offset:14336
  s_waitcnt lgkmcnt(15)
  v_mfma_f32_16x16x32_bf16 v[200:203], v[64:67], v[144:147], v[200:203]
  s_waitcnt lgkmcnt(14)
  v_mfma_f32_16x16x32_bf16 v[204:207], v[68:71], v[144:147], v[204:207]
  s_waitcnt lgkmcnt(13)
  v_mfma_f32_16x16x32_bf16 v[208:211], v[72:75], v[144:147], v[208:211]
  s_waitcnt lgkmcnt(12)
  v_mfma_f32_16x16x32_bf16 v[212:215], v[76:79], v[144:147], v[212:215]
  s_waitcnt lgkmcnt(11)
  v_mfma_f32_16x16x32_bf16 v[200:203], v[80:83], v[148:151], v[200:203]
  s_waitcnt lgkmcnt(10)
  v_mfma_f32_16x16x32_bf16 v[204:207], v[84:87], v[148:151], v[204:207]
  s_waitcnt lgkmcnt(9)
  v_mfma_f32_16x16x32_bf16 v[208:211], v[88:91], v[148:151], v[208:211]
  s_waitcnt lgkmcnt(8)
  v_mfma_f32_16x16x32_bf16 v[212:215], v[92:95], v[148:151], v[212:215]
  s_waitcnt lgkmcnt(7)
  ds_read_b128 v[64:67], v60 offset:16384
  ds_read_b128 v[68:71], v60 offset:18432
  ds_read_b128 v[72:75], v60 offset:20480
  ds_read_b128 v[76:79], v60 offset:22528
  ds_read_b128 v[80:83], v61 offset:16384
  ds_read_b128 v[84:87], v61 offset:18432
  ds_read_b128 v[88:91], v61 offset:20480
  ds_read_b128 v[92:95], v61 offset:22528
  s_waitcnt lgkmcnt(15)
  v_mfma_f32_16x16x32_bf16 v[200:203], v[96:99], v[152:155], v[200:203]
  s_waitcnt lgkmcnt(14)
  v_mfma_f32_16x16x32_bf16 v[204:207], v[100:103], v[152:155], v[204:207]
  s_waitcnt lgkmcnt(13)
  v_mfma_f32_16x16x32_bf16 v[208:211], v[104:107], v[152:155], v[208:211]
  s_waitcnt lgkmcnt(12)
  v_mfma_f32_16x16x32_bf16 v[212:215], v[108:111], v[152:155], v[212:215]
  s_waitcnt lgkmcnt(11)
  v_mfma_f32_16x16x32_bf16 v[200:203], v[112:115], v[156:159], v[200:203]
  s_waitcnt lgkmcnt(10)
  v_mfma_f32_16x16x32_bf16 v[204:207], v[116:119], v[156:159], v[204:207]
  s_waitcnt lgkmcnt(9)
  v_mfma_f32_16x16x32_bf16 v[208:211], v[120:123], v[156:159], v[208:211]
  s_waitcnt lgkmcnt(8)
  v_mfma_f32_16x16x32_bf16 v[212:215], v[124:127], v[156:159], v[212:215]
  s_waitcnt lgkmcnt(7)
  v_mfma_f32_16x16x32_bf16 v[200:203], v[64:67], v[160:163], v[200:203]
  s_waitcnt lgkmcnt(6)
  v_mfma_f32_16x16x32_bf16 v[204:207], v[68:71], v[160:163], v[204:207]
  s_waitcnt lgkmcnt(5)
  v_mfma_f32_16x16x32_bf16 v[208:211], v[72:75], v[160:163], v[208:211]
  s_waitcnt lgkmcnt(4)
  v_mfma_f32_16x16x32_bf16 v[212:215], v[76:79], v[160:163], v[212:215]
  s_waitcnt lgkmcnt(3)
  v_mfma_f32_16x16x32_bf16 v[200:203], v[80:83], v[164:167], v[200:203]
  s_waitcnt lgkmcnt(2)
  v_mfma_f32_16x16x32_bf16 v[204:207], v[84:87], v[164:167], v[204:207]
  s_waitcnt lgkmcnt(1)
  v_mfma_f32_16x16x32_bf16 v[208:211], v[88:91], v[164:167], v[208:211]
  s_waitcnt lgkmcnt(0)
  v_mfma_f32_16x16x32_bf16 v[212:215], v[92:95], v[164:167], v[212:215]
  v_mov_b32 v6, 162980
.Lsp_87:
  ds_read_b32 v7, v6
  s_waitcnt lgkmcnt(0)
  v_readfirstlane_b32 s79, v7
  s_cmp_lt_u32 s79, 4
  s_cbranch_scc1 .Lsp_87
  ds_read_b128 v[64:67], v60 offset:24576
  ds_read_b128 v[68:71], v60 offset:26624
  ds_read_b128 v[72:75], v60 offset:28672
  ds_read_b128 v[76:79], v60 offset:30720
  ds_read_b128 v[80:83], v61 offset:24576
  ds_read_b128 v[84:87], v61 offset:26624
  ds_read_b128 v[88:91], v61 offset:28672
  ds_read_b128 v[92:95], v61 offset:30720
  s_waitcnt lgkmcnt(7)
  ds_read_b128 v[96:99], v60 offset:32768
  ds_read_b128 v[100:103], v60 offset:34816
  ds_read_b128 v[104:107], v60 offset:36864
  ds_read_b128 v[108:111], v60 offset:38912
  ds_read_b128 v[112:115], v61 offset:32768
  ds_read_b128 v[116:119], v61 offset:34816
  ds_read_b128 v[120:123], v61 offset:36864
  ds_read_b128 v[124:127], v61 offset:38912
  s_waitcnt lgkmcnt(15)
  v_mfma_f32_16x16x32_bf16 v[200:203], v[64:67], v[168:171], v[200:203]
  s_waitcnt lgkmcnt(14)
  v_mfma_f32_16x16x32_bf16 v[204:207], v[68:71], v[168:171], v[204:207]
  s_waitcnt lgkmcnt(13)
  v_mfma_f32_16x16x32_bf16 v[208:211], v[72:75], v[168:171], v[208:211]
  s_waitcnt lgkmcnt(12)
  v_mfma_f32_16x16x32_bf16 v[212:215], v[76:79], v[168:171], v[212:215]
  s_waitcnt lgkmcnt(11)
  v_mfma_f32_16x16x32_bf16 v[200:203], v[80:83], v[172:175], v[200:203]
  s_waitcnt lgkmcnt(10)
  v_mfma_f32_16x16x32_bf16 v[204:207], v[84:87], v[172:175], v[204:207]
  s_waitcnt lgkmcnt(9)
  v_mfma_f32_16x16x32_bf16 v[208:211], v[88:91], v[172:175], v[208:211]
  s_waitcnt lgkmcnt(8)
  v_mfma_f32_16x16x32_bf16 v[212:215], v[92:95], v[172:175], v[212:215]
  s_waitcnt lgkmcnt(7)
  ds_read_b128 v[64:67], v60 offset:40960
  ds_read_b128 v[68:71], v60 offset:43008
  ds_read_b128 v[72:75], v60 offset:45056
  ds_read_b128 v[76:79], v60 offset:47104
  ds_read_b128 v[80:83], v61 offset:40960
  ds_read_b128 v[84:87], v61 offset:43008
  ds_read_b128 v[88:91], v61 offset:45056
  ds_read_b128 v[92:95], v61 offset:47104
  s_waitcnt lgkmcnt(15)
  v_mfma_f32_16x16x32_bf16 v[200:203], v[96:99], v[176:179], v[200:203]
  s_waitcnt lgkmcnt(14)
  v_mfma_f32_16x16x32_bf16 v[204:207], v[100:103], v[176:179], v[204:207]
  s_waitcnt lgkmcnt(13)
  v_mfma_f32_16x16x32_bf16 v[208:211], v[104:107], v[176:179], v[208:211]
  s_waitcnt lgkmcnt(12)
  v_mfma_f32_16x16x32_bf16 v[212:215], v[108:111], v[176:179], v[212:215]
  s_waitcnt lgkmcnt(11)
  v_mfma_f32_16x16x32_bf16 v[200:203], v[112:115], v[180:183], v[200:203]
  s_waitcnt lgkmcnt(10)
  v_mfma_f32_16x16x32_bf16 v[204:207], v[116:119], v[180:183], v[204:207]
  s_waitcnt lgkmcnt(9)
  v_mfma_f32_16x16x32_bf16 v[208:211], v[120:123], v[180:183], v[208:211]
  s_waitcnt lgkmcnt(8)
  v_mfma_f32_16x16x32_bf16 v[212:215], v[124:127], v[180:183], v[212:215]
  s_waitcnt lgkmcnt(7)
  ds_read_b128 v[96:99], v60 offset:49152
  ds_read_b128 v[100:103], v60 offset:51200
  ds_read_b128 v[104:107], v60 offset:53248
  ds_read_b128 v[108:111], v60 offset:55296
  ds_read_b128 v[112:115], v61 offset:49152
  ds_read_b128 v[116:119], v61 offset:51200
  ds_read_b128 v[120:123], v61 offset:53248
  ds_read_b128 v[124:127], v61 offset:55296
  s_waitcnt lgkmcnt(15)
  v_mfma_f32_16x16x32_bf16 v[200:203], v[64:67], v[184:187], v[200:203]
  s_waitcnt lgkmcnt(14)
  v_mfma_f32_16x16x32_bf16 v[204:207], v[68:71], v[184:187], v[204:207]
  s_waitcnt lgkmcnt(13)
  v_mfma_f32_16x16x32_bf16 v[208:211], v[72:75], v[184:187], v[208:211]
  s_waitcnt lgkmcnt(12)
  v_mfma_f32_16x16x32_bf16 v[212:215], v[76:79], v[184:187], v[212:215]
  s_waitcnt lgkmcnt(11)
  v_mfma_f32_16x16x32_bf16 v[200:203], v[80:83], v[188:191], v[200:203]
  s_waitcnt lgkmcnt(10)
  v_mfma_f32_16x16x32_bf16 v[204:207], v[84:87], v[188:191], v[204:207]
  s_waitcnt lgkmcnt(9)
  v_mfma_f32_16x16x32_bf16 v[208:211], v[88:91], v[188:191], v[208:211]
  s_waitcnt lgkmcnt(8)
  v_mfma_f32_16x16x32_bf16 v[212:215], v[92:95], v[188:191], v[212:215]
  s_waitcnt lgkmcnt(7)
  v_mfma_f32_16x16x32_bf16 v[200:203], v[96:99], v[192:195], v[200:203]
  s_waitcnt lgkmcnt(6)
  v_mfma_f32_16x16x32_bf16 v[204:207], v[100:103], v[192:195], v[204:207]
  s_waitcnt lgkmcnt(5)
  v_mfma_f32_16x16x32_bf16 v[208:211], v[104:107], v[192:195], v[208:211]
  s_waitcnt lgkmcnt(4)
  v_mfma_f32_16x16x32_bf16 v[212:215], v[108:111], v[192:195], v[212:215]
  s_waitcnt lgkmcnt(3)
  v_mfma_f32_16x16x32_bf16 v[200:203], v[112:115], v[196:199], v[200:203]
  s_waitcnt lgkmcnt(2)
  v_mfma_f32_16x16x32_bf16 v[204:207], v[116:119], v[196:199], v[204:207]
  s_waitcnt lgkmcnt(1)
  v_mfma_f32_16x16x32_bf16 v[208:211], v[120:123], v[196:199], v[208:211]
  s_waitcnt lgkmcnt(0)
  v_mfma_f32_16x16x32_bf16 v[212:215], v[124:127], v[196:199], v[212:215]
  s_waitcnt vmcnt(1)
  s_nop 6
  v_cvt_pk_bf16_f32 v80, v200, v201
  v_cvt_pk_bf16_f32 v81, v202, v203
  v_cvt_pk_bf16_f32 v82, v204, v205
  v_cvt_pk_bf16_f32 v83, v206, v207
  v_cvt_pk_bf16_f32 v84, v208, v209
  v_cvt_pk_bf16_f32 v85, v210, v211
  v_cvt_pk_bf16_f32 v86, v212, v213
  v_cvt_pk_bf16_f32 v87, v214, v215
  v_xor_b32 v88, v55, v80
  v_xor_b32 v89, v55, v81
  v_xor_b32 v90, v55, v82
  v_xor_b32 v91, v55, v83
  v_xor_b32 v92, v55, v84
  v_xor_b32 v93, v55, v85
  v_xor_b32 v94, v55, v86
  v_xor_b32 v95, v55, v87
  s_nop 1
  v_mfma_f32_16x16x32_bf16 v[96:99], v[16:19], v[88:91], 0
  v_mfma_f32_16x16x32_bf16 v[112:115], v[24:27], v[80:83], 0
  v_mfma_f32_16x16x32_bf16 v[100:103], v[20:23], v[88:91], 0
  v_mfma_f32_16x16x32_bf16 v[116:119], v[28:31], v[80:83], 0
  v_mfma_f32_16x16x32_bf16 v[104:107], v[16:19], v[92:95], 0
  v_mfma_f32_16x16x32_bf16 v[120:123], v[24:27], v[84:87], 0
  v_mfma_f32_16x16x32_bf16 v[108:111], v[20:23], v[92:95], 0
  v_mfma_f32_16x16x32_bf16 v[124:127], v[28:31], v[84:87], 0
  s_nop 7
  v_subrev_f32_dpp v96, v112, v96 row_ror:8 row_mask:0xf bank_mask:0xf
  v_subrev_f32_dpp v97, v113, v97 row_ror:8 row_mask:0xf bank_mask:0xf
  v_subrev_f32_dpp v98, v114, v98 row_ror:8 row_mask:0xf bank_mask:0xf
  v_subrev_f32_dpp v99, v115, v99 row_ror:8 row_mask:0xf bank_mask:0xf
  v_subrev_f32_dpp v100, v116, v100 row_ror:8 row_mask:0xf bank_mask:0xf
  v_subrev_f32_dpp v101, v117, v101 row_ror:8 row_mask:0xf bank_mask:0xf
  v_subrev_f32_dpp v102, v118, v102 row_ror:8 row_mask:0xf bank_mask:0xf
  v_subrev_f32_dpp v103, v119, v103 row_ror:8 row_mask:0xf bank_mask:0xf
  v_subrev_f32_dpp v104, v120, v104 row_ror:8 row_mask:0xf bank_mask:0xf
  v_subrev_f32_dpp v105, v121, v105 row_ror:8 row_mask:0xf bank_mask:0xf
  v_subrev_f32_dpp v106, v122, v106 row_ror:8 row_mask:0xf bank_mask:0xf
  v_subrev_f32_dpp v107, v123, v107 row_ror:8 row_mask:0xf bank_mask:0xf
  v_subrev_f32_dpp v108, v124, v108 row_ror:8 row_mask:0xf bank_mask:0xf
  v_subrev_f32_dpp v109, v125, v109 row_ror:8 row_mask:0xf bank_mask:0xf
  v_subrev_f32_dpp v110, v126, v110 row_ror:8 row_mask:0xf bank_mask:0xf
  v_subrev_f32_dpp v111, v127, v111 row_ror:8 row_mask:0xf bank_mask:0xf
  v_cvt_pk_bf16_f32 v64, v96, v104
  ds_write_b32 v53, v64 offset:0
  v_cvt_pk_bf16_f32 v65, v97, v105
  ds_write_b32 v53, v65 offset:128
  v_cvt_pk_bf16_f32 v66, v98, v106
  ds_write_b32 v53, v66 offset:256
  v_cvt_pk_bf16_f32 v67, v99, v107
  ds_write_b32 v53, v67 offset:384
  v_cvt_pk_bf16_f32 v68, v100, v108
  ds_write_b32 v53, v68 offset:2048
  v_cvt_pk_bf16_f32 v69, v101, v109
  ds_write_b32 v53, v69 offset:2176
  v_cvt_pk_bf16_f32 v70, v102, v110
  ds_write_b32 v53, v70 offset:2304
  v_cvt_pk_bf16_f32 v71, v103, v111
  ds_write_b32 v53, v71 offset:2432
  s_waitcnt lgkmcnt(0)
  s_mov_b64 exec, 1
  ds_add_u32 v56, v57
  s_mov_b64 exec, -1
  s_add_u32 s78, s78, 8
.Lfs_88:
  ds_read_b32 v58, v56
  s_waitcnt lgkmcnt(0)
  v_readfirstlane_b32 s79, v58
  s_cmp_lt_u32 s79, s78
  s_cbranch_scc1 .Lfs_88
  ds_read_b128 v[218:221], v59 offset:0
  ds_read_b128 v[222:225], v59 offset:1024
  v_mov_b32 v242, v52
  s_waitcnt lgkmcnt(0)
  s_setprio 0
  s_mov_b64 exec, 1
  ds_add_u32 v56, v57
  s_mov_b64 exec, -1
  v_lshrrev_b32 v6, 3, v0
  v_lshlrev_b32 v6, 7, v6
  v_and_b32 v7, 2, v0
  v_lshlrev_b32 v7, 5, v7
  v_and_b32 v8, 4, v0
  v_lshl_add_u32 v7, v8, 3, v7
  v_and_b32 v8, 1, v0
  v_lshl_add_u32 v7, v8, 4, v7
  v_add_u32 v251, v6, v7
  s_and_b32 s79, s3, 1
  s_lshl_b32 s79, s79, 7
  v_xor_b32 v250, s79, v251
  v_and_b32 v7, 4, v0
  v_lshlrev_b32 v7, 4, v7
  v_and_b32 v8, 1, v0
  v_lshl_add_u32 v7, v8, 5, v7
  v_and_b32 v8, 2, v0
  v_lshl_add_u32 v7, v8, 3, v7
  v_add_u32 v252, v6, v7
  s_branch .Lc_pub
.Lcode_end:
.section .rodata,"a"
.p2align 6
.amdhsa_kernel concat_heads__spectral_fnet__softmax_full_mha__prompt_kernel
  .amdhsa_next_free_vgpr 256
  .amdhsa_next_free_sgpr 102
  .amdhsa_accum_offset 256
  .amdhsa_group_segment_fixed_size 0
  .amdhsa_kernarg_size 88
  .amdhsa_user_sgpr_count 2
  .amdhsa_user_sgpr_kernarg_segment_ptr 1
  .amdhsa_system_sgpr_workgroup_id_x 1
.end_amdhsa_kernel
```
